```python
import torch

def _softmax(x, axis=-1):
    return torch.softmax(x, dim=axis)
def _gelu(x):
    return torch.nn.functional.gelu(x, approximate="tanh")
def _silu(x):
    return torch.nn.functional.silu(x)
def _sigmoid(x):
    return torch.sigmoid(x)
def _layernorm(x, axis=-1, eps=1e-5):
    m = x.mean(dim=axis, keepdim=True)
    v = x.var(dim=axis, keepdim=True, unbiased=False)
    return (x - m) / torch.sqrt(v + eps)
def _scatter_add(tgt, idx, src, axis=0):
    return tgt.clone().index_add_(axis, idx, src)
def _segment_sum(src, seg, n):
    out = torch.zeros((n,) + src.shape[1:], dtype=src.dtype)
    return out.index_add_(0, seg, src)
def _pad(x, pw):
    flat = tuple(v for pair in reversed(pw) for v in pair)
    return torch.nn.functional.pad(x, flat)

kernel_name = 'sequential_preLN__sliding_block__geglu_ffn__prompt'

def setup_inputs():

    _w = (lambda a: (lambda t: t.to(torch.bfloat16) if t.is_floating_point() else t)(torch.as_tensor(a)))
    def _A_setup():
        B, S, D = 1, 2048, 512
        return {
            "x": _w((lambda *s: torch.randn(*s, dtype=torch.bfloat16) * 0.05)(B, S, D)),
            "wqkv": _w((lambda *s: torch.randn(*s, dtype=torch.bfloat16) * 0.05)(D, 3 * D)),
            "wo": _w((lambda *s: torch.randn(*s, dtype=torch.bfloat16) * 0.05)(D, D)),
        }
    _A_in = _A_setup()

    def _B_setup():
        B, S, D, F = 1, 2048, 512, 1792
        return {
            "x": _w((lambda *s: torch.randn(*s, dtype=torch.bfloat16) * 0.05)(B, S, D)),
            "w_gate": _w((lambda *s: torch.randn(*s, dtype=torch.bfloat16) * 0.05)(D, F)),
            "w_up": _w((lambda *s: torch.randn(*s, dtype=torch.bfloat16) * 0.05)(D, F)),
            "w_down": _w((lambda *s: torch.randn(*s, dtype=torch.bfloat16) * 0.05)(F, D)),
        }
    _B_in = _B_setup()

    return {
        "A_x": _A_in["x"],
        "A_wqkv": _A_in["wqkv"],
        "A_wo": _A_in["wo"],
        "B_x": _B_in["x"],
        "B_w_gate": _B_in["w_gate"],
        "B_w_up": _B_in["w_up"],
        "B_w_down": _B_in["w_down"],
    }

def reference(A_x, A_wqkv, A_wo, B_x, B_w_gate, B_w_up, B_w_down):
    def _A_ref(x, wqkv, wo):
        B, S, D = x.shape
        H = 32; Dh = D // H; W = 256
        qkv = (lambda x, *d: x.permute(*d))((x @ wqkv).reshape(B, S, 3, H, Dh), 2, 0, 3, 1, 4)
        q, k, v = qkv[0], qkv[1], qkv[2]
        scores = torch.einsum("bhqd,bhkd->bhqk", q, k) * (Dh ** -0.5)
        idx = torch.arange(S)
        mask = (idx[:, None] - idx[None, :] >= 0) & (idx[:, None] - idx[None, :] < W)
        scores = torch.where(mask[None, None], scores, -1e9)
        p = _softmax(scores, axis=-1)
        o = torch.einsum("bhqk,bhkd->bhqd", p, v)
        return (lambda x, *d: x.permute(*d))(o, 0, 2, 1, 3).reshape(B, S, D) @ wo

    def _B_ref(x, w_gate, w_up, w_down):
        return (_gelu(x @ w_gate) * (x @ w_up)) @ w_down

    x = A_x
    h = x + _A_ref(_layernorm(x, axis=-1), A_wqkv, A_wo)
    h2 = h + _B_ref(_layernorm(h, axis=-1), B_w_gate, B_w_up, B_w_down)
    return h2
```

```asm
; @launch grid=(256,1,1) block=(512,1,1) lds=163840
.amdgcn_target "amdgcn-amd-amdhsa--gfx950"
.text
.globl sequential_preLN__sliding_block__geglu_ffn__prompt_kernel
.p2align 8
.type sequential_preLN__sliding_block__geglu_ffn__prompt_kernel,@function
sequential_preLN__sliding_block__geglu_ffn__prompt_kernel:
  s_cmp_ge_u32 s2, 256
  s_cbranch_scc1 Lend
  s_load_dwordx16 s[8:23], s[0:1], 0
  s_load_dwordx4 s[24:27], s[0:1], 64
  v_and_b32 v1, 63, v0
  v_lshrrev_b32 v2, 6, v0
  s_nop 0
  v_readfirstlane_b32 s48, v2
  s_mov_b32 s60, 0x3f803f80
  s_lshl_b32 s51, s48, 10
  s_and_b32 s54, s2, 7
  s_lshr_b32 s55, s2, 3
  s_lshl_b32 s49, s54, 2
  s_lshr_b32 s56, s55, 3
  s_add_u32 s49, s49, s56
  s_and_b32 s50, s55, 7
  s_lshl_b32 s5, s54, 1
  s_lshr_b32 s56, s55, 4
  s_add_u32 s5, s5, s56
  s_and_b32 s6, s55, 15
  s_mov_b32 s4, 0
  s_cmp_eq_u32 s48, 2
  s_cbranch_scc0 Lc_1
  s_getpc_b64 s[70:71]
Lpc0:
  s_sub_u32 s70, s70, Lpc0-sequential_preLN__sliding_block__geglu_ffn__prompt_kernel
  s_subb_u32 s71, s71, 0
  s_lshr_b32 s54, s2, 3
  s_lshl_b32 s54, s54, 11
  v_lshlrev_b32 v9, 4, v1
  v_add_u32 v9, s54, v9
  v_add_u32 v8, 1024, v9
  s_mov_b32 s54, Lend-sequential_preLN__sliding_block__geglu_ffn__prompt_kernel-16
  v_min_u32 v9, s54, v9
  v_min_u32 v8, s54, v8
  global_load_dwordx4 v[240:243], v9, s[70:71]
  global_load_dwordx4 v[240:243], v8, s[70:71]
Lc_1:
  s_waitcnt lgkmcnt(0)
  s_and_b32 s54, s2, 7
  s_lshr_b32 s55, s2, 3
  s_and_b32 s0, s54, 1
  s_lshl_b32 s0, s0, 3
  s_lshr_b32 s56, s55, 2
  s_add_u32 s0, s0, s56
  s_lshr_b32 s1, s54, 1
  s_lshl_b32 s1, s1, 2
  s_and_b32 s56, s55, 3
  s_add_u32 s1, s1, s56
  s_mov_b32 s5, s0
  s_mov_b32 s6, s1
  s_add_u32 s44, s26, 11010048
  s_addc_u32 s45, s27, 0
  s_mov_b32 s46, 196608
  s_mov_b32 s47, 0x20000
  s_mov_b32 s72, s49
  s_mov_b32 s73, s50
  s_and_b32 s54, s2, 7
  s_lshr_b32 s55, s2, 3
  s_and_b32 s49, s54, 1
  s_lshl_b32 s49, s49, 4
  s_lshr_b32 s56, s55, 1
  s_add_u32 s49, s49, s56
  s_lshr_b32 s50, s54, 1
  s_lshl_b32 s50, s50, 1
  s_and_b32 s56, s55, 1
  s_add_u32 s50, s50, s56
  s_cmp_ge_u32 s48, 4
  s_cbranch_scc1 Lprod_2
  v_lshlrev_b32 v9, 4, v1
  s_mov_b32 s40, s10
  s_mov_b32 s41, s11
  s_mov_b32 s42, 1572864
  s_mov_b32 s43, 0x20000
  s_mul_i32 s54, s2, 6144
  s_add_u32 s54, s54, s51
  buffer_load_dwordx4 v[240:243], v9, s[40:43], s54 offen
  s_add_u32 s54, s54, 4096
  s_cmp_lt_u32 s48, 2
  s_cbranch_scc0 Ll_4
  buffer_load_dwordx4 v[240:243], v9, s[40:43], s54 offen
Ll_4:
  s_add_u32 s54, s54, 4096
  s_mov_b32 s40, s8
  s_mov_b32 s41, s9
  s_mov_b32 s42, 2097152
  s_mov_b32 s43, 0x20000
  s_mul_i32 s54, s2, 8192
  s_add_u32 s54, s54, s51
  buffer_load_dwordx4 v[240:243], v9, s[40:43], s54 offen
  s_add_u32 s54, s54, 4096
  buffer_load_dwordx4 v[240:243], v9, s[40:43], s54 offen
  s_add_u32 s54, s54, 4096
  s_or_b32 s54, s2, s48
  s_cmp_eq_u32 s54, 0
  s_cbranch_scc0 Ln_5
  v_mov_b32 v3, 10878976
  global_load_dword v2, v3, s[26:27] sc1
  s_waitcnt vmcnt(0)
  v_add_u32 v2, 32, v2
  v_max_u32 v2, 1, v2
  global_store_dword v3, v2, s[26:27] sc1
  v_mov_b32 v3, 0
  global_store_dword v3, v2, s[24:25] sc1
Ln_5:
  s_mov_b32 s36, s26
  s_mov_b32 s37, s27
  s_mov_b32 s38, 6291456
  s_mov_b32 s39, 0x20000
  s_lshr_b32 s52, s48, 1
  s_and_b32 s53, s48, 1
  s_lshl_b32 s57, s52, 12
  s_lshl_b32 s58, s53, 11
  s_add_u32 s59, s57, s58
  v_and_b32 v2, 15, v1
  v_lshrrev_b32 v3, 4, v1
  v_and_b32 v4, 7, v2
  v_xor_b32 v3, v3, v4
  v_lshlrev_b32 v3, 4, v3
  v_lshl_add_u32 v12, v2, 7, v3
  v_add_u32 v12, s59, v12
  v_xor_b32 v13, 64, v12
  v_xor_b32 v14, 2048, v12
  v_xor_b32 v15, 2048, v13
  v_add_u32 v16, 0x10000, v12
  v_add_u32 v17, 0x10000, v13
  v_add_u32 v18, 0x10000, v14
  v_add_u32 v19, 0x10000, v15
  s_lshl_b32 s55, s53, 1
  s_add_u32 s55, s55, 0
  v_lshrrev_b32 v2, 4, v1
  v_bfe_u32 v3, v1, 2, 2
  v_lshl_add_u32 v20, v2, 3, v3
  v_lshlrev_b32 v20, 7, v20
  v_bfe_u32 v3, v1, 3, 1
  v_and_b32 v2, 1, v2
  v_lshl_add_u32 v3, v2, 1, v3
  v_xor_b32 v3, s55, v3
  v_lshl_add_u32 v20, v3, 5, v20
  v_and_b32 v4, 3, v1
  v_lshl_add_u32 v20, v4, 3, v20
  v_lshrrev_b32 v2, 4, v1
  v_bfe_u32 v3, v1, 2, 2
  v_lshl_add_u32 v21, v2, 3, v3
  v_lshlrev_b32 v21, 7, v21
  v_bfe_u32 v3, v1, 3, 1
  v_and_b32 v2, 1, v2
  v_lshl_add_u32 v3, v2, 1, v3
  v_xor_b32 v3, s55, v3
  v_lshl_add_u32 v21, v3, 5, v21
  v_and_b32 v4, 3, v1
  v_bfe_u32 v2, v4, 1, 1
  v_and_b32 v4, 1, v4
  v_lshl_add_u32 v4, v4, 1, v2
  v_lshl_add_u32 v21, v4, 3, v21
  v_add_u32 v24, 0x10000, v20
  v_add_u32 v25, 0x10000, v21
  s_lshl_b32 s55, s53, 1
  s_add_u32 s55, s55, 1
  v_lshrrev_b32 v2, 4, v1
  v_bfe_u32 v3, v1, 2, 2
  v_lshl_add_u32 v22, v2, 3, v3
  v_lshlrev_b32 v22, 7, v22
  v_bfe_u32 v3, v1, 3, 1
  v_and_b32 v2, 1, v2
  v_lshl_add_u32 v3, v2, 1, v3
  v_xor_b32 v3, s55, v3
  v_lshl_add_u32 v22, v3, 5, v22
  v_and_b32 v4, 3, v1
  v_lshl_add_u32 v22, v4, 3, v22
  v_lshrrev_b32 v2, 4, v1
  v_bfe_u32 v3, v1, 2, 2
  v_lshl_add_u32 v23, v2, 3, v3
  v_lshlrev_b32 v23, 7, v23
  v_bfe_u32 v3, v1, 3, 1
  v_and_b32 v2, 1, v2
  v_lshl_add_u32 v3, v2, 1, v3
  v_xor_b32 v3, s55, v3
  v_lshl_add_u32 v23, v3, 5, v23
  v_and_b32 v4, 3, v1
  v_bfe_u32 v2, v4, 1, 1
  v_and_b32 v4, 1, v4
  v_lshl_add_u32 v4, v4, 1, v2
  v_lshl_add_u32 v23, v4, 3, v23
  v_add_u32 v26, 0x10000, v22
  v_add_u32 v27, 0x10000, v23
  v_mov_b64 v[28:29], 0
  v_mov_b64 v[30:31], 0
  v_mov_b64 v[32:33], 0
  v_mov_b64 v[34:35], 0
  v_mov_b64 v[36:37], 0
  v_mov_b64 v[38:39], 0
  v_mov_b64 v[40:41], 0
  v_mov_b64 v[42:43], 0
  v_mov_b64 v[44:45], 0
  v_mov_b64 v[46:47], 0
  v_mov_b64 v[48:49], 0
  v_mov_b64 v[50:51], 0
  v_mov_b64 v[52:53], 0
  v_mov_b64 v[54:55], 0
  v_mov_b64 v[56:57], 0
  v_mov_b64 v[58:59], 0
  v_mov_b64 v[60:61], 0
  v_mov_b64 v[62:63], 0
  v_mov_b64 v[64:65], 0
  v_mov_b64 v[66:67], 0
  v_mov_b64 v[68:69], 0
  v_mov_b64 v[70:71], 0
  v_mov_b64 v[72:73], 0
  v_mov_b64 v[74:75], 0
  v_mov_b64 v[76:77], 0
  v_mov_b64 v[78:79], 0
  v_mov_b64 v[80:81], 0
  v_mov_b64 v[82:83], 0
  v_mov_b64 v[84:85], 0
  v_mov_b64 v[86:87], 0
  v_mov_b64 v[88:89], 0
  v_mov_b64 v[90:91], 0
  v_mov_b64 v[92:93], 0
  v_mov_b64 v[94:95], 0
  v_mov_b64 v[96:97], 0
  v_mov_b64 v[98:99], 0
  v_mov_b64 v[100:101], 0
  v_mov_b64 v[102:103], 0
  v_mov_b64 v[104:105], 0
  v_mov_b64 v[106:107], 0
  v_mov_b32 v108, s60
  v_mov_b32 v109, s60
  v_mov_b32 v110, s60
  v_mov_b32 v111, s60
  v_and_b32 v2, 15, v1
  v_lshrrev_b32 v3, 4, v1
  v_and_b32 v184, 3, v2
  v_lshrrev_b32 v5, 2, v2
  v_xor_b32 v185, v5, v3
  s_lshr_b32 s54, s59, 5
  v_lshl_add_u32 v186, v2, 2, s54
  v_xor_b32 v187, 64, v186
  v_lshl_add_u32 v192, v3, 4, s54
  v_xor_b32 v193, 64, v192
  s_mul_i32 s55, s48, 384
  v_lshl_add_u32 v188, v3, 4, s55
  v_lshl_add_u32 v189, v2, 2, s55
  s_xor_b32 s56, s48, 2
  s_mul_i32 s56, s56, 384
  v_lshl_add_u32 v190, v3, 4, s56
  v_lshl_add_u32 v191, v2, 2, s56
  s_lshl_b32 s54, s50, 2
  s_lshl_b32 s55, s53, 1
  s_add_u32 s54, s54, s55
  s_lshl_b32 s54, s54, 16
  s_lshl_b32 s55, s49, 11
  s_add_u32 s54, s54, s55
  s_lshr_b32 s55, s59, 2
  s_add_u32 s54, s54, s55
  v_lshlrev_b32 v7, 5, v2
  v_lshl_add_u32 v8, v3, 3, v7
  v_add_u32 v194, s54, v8
  v_xor_b32 v195, 512, v194
  v_and_b32 v9, 1, v3
  v_lshrrev_b32 v6, 1, v3
  v_lshl_add_u32 v9, v9, 1, v6
  v_lshl_add_u32 v9, v9, 3, v7
  v_add_u32 v196, s54, v9
  v_xor_b32 v197, 512, v196
  s_mov_b32 s64, 0
  s_mov_b32 s65, 2097152
  s_mov_b32 s66, 4194304
  s_mov_b32 s67, 65536
  s_mov_b32 s68, 2162688
  s_mov_b32 s69, 4259840
  s_barrier
  ds_read_b128 v[112:115], v12 offset:0
  ds_read_b128 v[116:119], v14 offset:0
  ds_read_b64_tr_b16 v[120:121], v20 offset:8192
  ds_read_b64_tr_b16 v[122:123], v20 offset:8704
  ds_read_b64_tr_b16 v[124:125], v20 offset:16384
  ds_read_b64_tr_b16 v[126:127], v20 offset:16896
  ds_read_b64_tr_b16 v[128:129], v21 offset:24576
  ds_read_b64_tr_b16 v[130:131], v21 offset:25088
  ds_read_b64_tr_b16 v[132:133], v22 offset:8192
  ds_read_b64_tr_b16 v[134:135], v22 offset:8704
  ds_read_b64_tr_b16 v[136:137], v22 offset:16384
  ds_read_b64_tr_b16 v[138:139], v22 offset:16896
  ds_read_b64_tr_b16 v[140:141], v23 offset:24576
  ds_read_b64_tr_b16 v[142:143], v23 offset:25088
  s_waitcnt lgkmcnt(0)
  v_mfma_f32_16x16x32_bf16 v[28:31], v[120:123], v[112:115], v[28:31]
  ds_read_b128 v[144:147], v13 offset:0
  ds_read_b128 v[148:151], v15 offset:0
  v_mfma_f32_16x16x32_bf16 v[32:35], v[120:123], v[116:119], v[32:35]
  ds_read_b64_tr_b16 v[152:153], v20 offset:12288
  v_mfma_f32_16x16x32_bf16 v[36:39], v[124:127], v[112:115], v[36:39]
  ds_read_b64_tr_b16 v[154:155], v20 offset:12800
  ds_read_b64_tr_b16 v[156:157], v20 offset:20480
  v_mfma_f32_16x16x32_bf16 v[40:43], v[124:127], v[116:119], v[40:43]
  ds_read_b64_tr_b16 v[158:159], v20 offset:20992
  v_mfma_f32_16x16x32_bf16 v[100:103], v[108:111], v[112:115], v[100:103]
  ds_read_b64_tr_b16 v[160:161], v21 offset:28672
  v_mfma_f32_16x16x32_bf16 v[44:47], v[112:115], v[128:131], v[44:47]
  ds_read_b64_tr_b16 v[162:163], v21 offset:29184
  ds_read_b64_tr_b16 v[164:165], v22 offset:12288
  v_mfma_f32_16x16x32_bf16 v[48:51], v[116:119], v[128:131], v[48:51]
  ds_read_b64_tr_b16 v[166:167], v22 offset:12800
  v_mfma_f32_16x16x32_bf16 v[52:55], v[132:135], v[112:115], v[52:55]
  ds_read_b64_tr_b16 v[168:169], v22 offset:20480
  ds_read_b64_tr_b16 v[170:171], v22 offset:20992
  v_mfma_f32_16x16x32_bf16 v[56:59], v[132:135], v[116:119], v[56:59]
  ds_read_b64_tr_b16 v[172:173], v23 offset:28672
  v_mfma_f32_16x16x32_bf16 v[104:107], v[112:115], v[112:115], v[104:107]
  ds_read_b64_tr_b16 v[174:175], v23 offset:29184
  v_mfma_f32_16x16x32_bf16 v[60:63], v[136:139], v[112:115], v[60:63]
  v_mfma_f32_16x16x32_bf16 v[64:67], v[136:139], v[116:119], v[64:67]
  v_mfma_f32_16x16x32_bf16 v[68:71], v[112:115], v[140:143], v[68:71]
  v_mfma_f32_16x16x32_bf16 v[72:75], v[116:119], v[140:143], v[72:75]
  s_cmp_eq_u32 s52, 0
  s_cbranch_scc0 Lg_6
  v_mfma_f32_16x16x32_bf16 v[76:79], v[120:123], v[108:111], v[76:79]
  v_mfma_f32_16x16x32_bf16 v[80:83], v[124:127], v[108:111], v[80:83]
  v_mfma_f32_16x16x32_bf16 v[84:87], v[108:111], v[128:131], v[84:87]
  v_mfma_f32_16x16x32_bf16 v[88:91], v[132:135], v[108:111], v[88:91]
  v_mfma_f32_16x16x32_bf16 v[92:95], v[136:139], v[108:111], v[92:95]
  v_mfma_f32_16x16x32_bf16 v[96:99], v[108:111], v[140:143], v[96:99]
Lg_6:
  s_waitcnt lgkmcnt(0)
  s_barrier
  v_mfma_f32_16x16x32_bf16 v[28:31], v[152:155], v[144:147], v[28:31]
  ds_read_b128 v[112:115], v12 offset:32768
  ds_read_b128 v[116:119], v14 offset:32768
  v_mfma_f32_16x16x32_bf16 v[32:35], v[152:155], v[148:151], v[32:35]
  ds_read_b64_tr_b16 v[120:121], v20 offset:40960
  v_mfma_f32_16x16x32_bf16 v[36:39], v[156:159], v[144:147], v[36:39]
  ds_read_b64_tr_b16 v[122:123], v20 offset:41472
  ds_read_b64_tr_b16 v[124:125], v20 offset:49152
  v_mfma_f32_16x16x32_bf16 v[40:43], v[156:159], v[148:151], v[40:43]
  ds_read_b64_tr_b16 v[126:127], v20 offset:49664
  v_mfma_f32_16x16x32_bf16 v[100:103], v[108:111], v[144:147], v[100:103]
  ds_read_b64_tr_b16 v[128:129], v21 offset:57344
  v_mfma_f32_16x16x32_bf16 v[44:47], v[144:147], v[160:163], v[44:47]
  ds_read_b64_tr_b16 v[130:131], v21 offset:57856
  ds_read_b64_tr_b16 v[132:133], v22 offset:40960
  v_mfma_f32_16x16x32_bf16 v[48:51], v[148:151], v[160:163], v[48:51]
  ds_read_b64_tr_b16 v[134:135], v22 offset:41472
  v_mfma_f32_16x16x32_bf16 v[52:55], v[164:167], v[144:147], v[52:55]
  ds_read_b64_tr_b16 v[136:137], v22 offset:49152
  ds_read_b64_tr_b16 v[138:139], v22 offset:49664
  v_mfma_f32_16x16x32_bf16 v[56:59], v[164:167], v[148:151], v[56:59]
  ds_read_b64_tr_b16 v[140:141], v23 offset:57344
  v_mfma_f32_16x16x32_bf16 v[104:107], v[144:147], v[144:147], v[104:107]
  ds_read_b64_tr_b16 v[142:143], v23 offset:57856
  v_mfma_f32_16x16x32_bf16 v[60:63], v[168:171], v[144:147], v[60:63]
  v_mfma_f32_16x16x32_bf16 v[64:67], v[168:171], v[148:151], v[64:67]
  v_mfma_f32_16x16x32_bf16 v[68:71], v[144:147], v[172:175], v[68:71]
  v_mfma_f32_16x16x32_bf16 v[72:75], v[148:151], v[172:175], v[72:75]
  s_cmp_eq_u32 s52, 1
  s_cbranch_scc0 Lg_7
  v_mfma_f32_16x16x32_bf16 v[76:79], v[152:155], v[108:111], v[76:79]
  v_mfma_f32_16x16x32_bf16 v[80:83], v[156:159], v[108:111], v[80:83]
  v_mfma_f32_16x16x32_bf16 v[84:87], v[108:111], v[160:163], v[84:87]
  v_mfma_f32_16x16x32_bf16 v[88:91], v[164:167], v[108:111], v[88:91]
  v_mfma_f32_16x16x32_bf16 v[92:95], v[168:171], v[108:111], v[92:95]
  v_mfma_f32_16x16x32_bf16 v[96:99], v[108:111], v[172:175], v[96:99]
Lg_7:
  s_waitcnt lgkmcnt(0)
  v_mfma_f32_16x16x32_bf16 v[28:31], v[120:123], v[112:115], v[28:31]
  ds_read_b128 v[144:147], v13 offset:32768
  ds_read_b128 v[148:151], v15 offset:32768
  v_mfma_f32_16x16x32_bf16 v[32:35], v[120:123], v[116:119], v[32:35]
  ds_read_b64_tr_b16 v[152:153], v20 offset:45056
  v_mfma_f32_16x16x32_bf16 v[36:39], v[124:127], v[112:115], v[36:39]
  ds_read_b64_tr_b16 v[154:155], v20 offset:45568
  ds_read_b64_tr_b16 v[156:157], v20 offset:53248
  v_mfma_f32_16x16x32_bf16 v[40:43], v[124:127], v[116:119], v[40:43]
  ds_read_b64_tr_b16 v[158:159], v20 offset:53760
  v_mfma_f32_16x16x32_bf16 v[100:103], v[108:111], v[112:115], v[100:103]
  ds_read_b64_tr_b16 v[160:161], v21 offset:61440
  v_mfma_f32_16x16x32_bf16 v[44:47], v[112:115], v[128:131], v[44:47]
  ds_read_b64_tr_b16 v[162:163], v21 offset:61952
  ds_read_b64_tr_b16 v[164:165], v22 offset:45056
  v_mfma_f32_16x16x32_bf16 v[48:51], v[116:119], v[128:131], v[48:51]
  ds_read_b64_tr_b16 v[166:167], v22 offset:45568
  v_mfma_f32_16x16x32_bf16 v[52:55], v[132:135], v[112:115], v[52:55]
  ds_read_b64_tr_b16 v[168:169], v22 offset:53248
  ds_read_b64_tr_b16 v[170:171], v22 offset:53760
  v_mfma_f32_16x16x32_bf16 v[56:59], v[132:135], v[116:119], v[56:59]
  ds_read_b64_tr_b16 v[172:173], v23 offset:61440
  v_mfma_f32_16x16x32_bf16 v[104:107], v[112:115], v[112:115], v[104:107]
  ds_read_b64_tr_b16 v[174:175], v23 offset:61952
  v_mfma_f32_16x16x32_bf16 v[60:63], v[136:139], v[112:115], v[60:63]
  v_mfma_f32_16x16x32_bf16 v[64:67], v[136:139], v[116:119], v[64:67]
  v_mfma_f32_16x16x32_bf16 v[68:71], v[112:115], v[140:143], v[68:71]
  v_mfma_f32_16x16x32_bf16 v[72:75], v[116:119], v[140:143], v[72:75]
  s_cmp_eq_u32 s52, 0
  s_cbranch_scc0 Lg_8
  v_mfma_f32_16x16x32_bf16 v[76:79], v[120:123], v[108:111], v[76:79]
  v_mfma_f32_16x16x32_bf16 v[80:83], v[124:127], v[108:111], v[80:83]
  v_mfma_f32_16x16x32_bf16 v[84:87], v[108:111], v[128:131], v[84:87]
  v_mfma_f32_16x16x32_bf16 v[88:91], v[132:135], v[108:111], v[88:91]
  v_mfma_f32_16x16x32_bf16 v[92:95], v[136:139], v[108:111], v[92:95]
  v_mfma_f32_16x16x32_bf16 v[96:99], v[108:111], v[140:143], v[96:99]
Lg_8:
  s_waitcnt lgkmcnt(0)
  s_barrier
  v_mfma_f32_16x16x32_bf16 v[28:31], v[152:155], v[144:147], v[28:31]
  ds_read_b128 v[112:115], v16 offset:0
  ds_read_b128 v[116:119], v18 offset:0
  v_mfma_f32_16x16x32_bf16 v[32:35], v[152:155], v[148:151], v[32:35]
  ds_read_b64_tr_b16 v[120:121], v24 offset:8192
  v_mfma_f32_16x16x32_bf16 v[36:39], v[156:159], v[144:147], v[36:39]
  ds_read_b64_tr_b16 v[122:123], v24 offset:8704
  ds_read_b64_tr_b16 v[124:125], v24 offset:16384
  v_mfma_f32_16x16x32_bf16 v[40:43], v[156:159], v[148:151], v[40:43]
  ds_read_b64_tr_b16 v[126:127], v24 offset:16896
  v_mfma_f32_16x16x32_bf16 v[100:103], v[108:111], v[144:147], v[100:103]
  ds_read_b64_tr_b16 v[128:129], v25 offset:24576
  v_mfma_f32_16x16x32_bf16 v[44:47], v[144:147], v[160:163], v[44:47]
  ds_read_b64_tr_b16 v[130:131], v25 offset:25088
  ds_read_b64_tr_b16 v[132:133], v26 offset:8192
  v_mfma_f32_16x16x32_bf16 v[48:51], v[148:151], v[160:163], v[48:51]
  ds_read_b64_tr_b16 v[134:135], v26 offset:8704
  v_mfma_f32_16x16x32_bf16 v[52:55], v[164:167], v[144:147], v[52:55]
  ds_read_b64_tr_b16 v[136:137], v26 offset:16384
  ds_read_b64_tr_b16 v[138:139], v26 offset:16896
  v_mfma_f32_16x16x32_bf16 v[56:59], v[164:167], v[148:151], v[56:59]
  ds_read_b64_tr_b16 v[140:141], v27 offset:24576
  v_mfma_f32_16x16x32_bf16 v[104:107], v[144:147], v[144:147], v[104:107]
  ds_read_b64_tr_b16 v[142:143], v27 offset:25088
  v_mfma_f32_16x16x32_bf16 v[60:63], v[168:171], v[144:147], v[60:63]
  v_mfma_f32_16x16x32_bf16 v[64:67], v[168:171], v[148:151], v[64:67]
  v_mfma_f32_16x16x32_bf16 v[68:71], v[144:147], v[172:175], v[68:71]
  v_mfma_f32_16x16x32_bf16 v[72:75], v[148:151], v[172:175], v[72:75]
  s_cmp_eq_u32 s52, 1
  s_cbranch_scc0 Lg_9
  v_mfma_f32_16x16x32_bf16 v[76:79], v[152:155], v[108:111], v[76:79]
  v_mfma_f32_16x16x32_bf16 v[80:83], v[156:159], v[108:111], v[80:83]
  v_mfma_f32_16x16x32_bf16 v[84:87], v[108:111], v[160:163], v[84:87]
  v_mfma_f32_16x16x32_bf16 v[88:91], v[164:167], v[108:111], v[88:91]
  v_mfma_f32_16x16x32_bf16 v[92:95], v[168:171], v[108:111], v[92:95]
  v_mfma_f32_16x16x32_bf16 v[96:99], v[108:111], v[172:175], v[96:99]
Lg_9:
  s_waitcnt lgkmcnt(0)
  v_mfma_f32_16x16x32_bf16 v[28:31], v[120:123], v[112:115], v[28:31]
  ds_read_b128 v[144:147], v17 offset:0
  ds_read_b128 v[148:151], v19 offset:0
  v_mfma_f32_16x16x32_bf16 v[32:35], v[120:123], v[116:119], v[32:35]
  ds_read_b64_tr_b16 v[152:153], v24 offset:12288
  v_mfma_f32_16x16x32_bf16 v[36:39], v[124:127], v[112:115], v[36:39]
  ds_read_b64_tr_b16 v[154:155], v24 offset:12800
  ds_read_b64_tr_b16 v[156:157], v24 offset:20480
  v_mfma_f32_16x16x32_bf16 v[40:43], v[124:127], v[116:119], v[40:43]
  ds_read_b64_tr_b16 v[158:159], v24 offset:20992
  v_mfma_f32_16x16x32_bf16 v[100:103], v[108:111], v[112:115], v[100:103]
  ds_read_b64_tr_b16 v[160:161], v25 offset:28672
  v_mfma_f32_16x16x32_bf16 v[44:47], v[112:115], v[128:131], v[44:47]
  ds_read_b64_tr_b16 v[162:163], v25 offset:29184
  ds_read_b64_tr_b16 v[164:165], v26 offset:12288
  v_mfma_f32_16x16x32_bf16 v[48:51], v[116:119], v[128:131], v[48:51]
  ds_read_b64_tr_b16 v[166:167], v26 offset:12800
  v_mfma_f32_16x16x32_bf16 v[52:55], v[132:135], v[112:115], v[52:55]
  ds_read_b64_tr_b16 v[168:169], v26 offset:20480
  ds_read_b64_tr_b16 v[170:171], v26 offset:20992
  v_mfma_f32_16x16x32_bf16 v[56:59], v[132:135], v[116:119], v[56:59]
  ds_read_b64_tr_b16 v[172:173], v27 offset:28672
  v_mfma_f32_16x16x32_bf16 v[104:107], v[112:115], v[112:115], v[104:107]
  ds_read_b64_tr_b16 v[174:175], v27 offset:29184
  v_mfma_f32_16x16x32_bf16 v[60:63], v[136:139], v[112:115], v[60:63]
  v_mfma_f32_16x16x32_bf16 v[64:67], v[136:139], v[116:119], v[64:67]
  v_mfma_f32_16x16x32_bf16 v[68:71], v[112:115], v[140:143], v[68:71]
  v_mfma_f32_16x16x32_bf16 v[72:75], v[116:119], v[140:143], v[72:75]
  s_cmp_eq_u32 s52, 0
  s_cbranch_scc0 Lg_10
  v_mfma_f32_16x16x32_bf16 v[76:79], v[120:123], v[108:111], v[76:79]
  v_mfma_f32_16x16x32_bf16 v[80:83], v[124:127], v[108:111], v[80:83]
  v_mfma_f32_16x16x32_bf16 v[84:87], v[108:111], v[128:131], v[84:87]
  v_mfma_f32_16x16x32_bf16 v[88:91], v[132:135], v[108:111], v[88:91]
  v_mfma_f32_16x16x32_bf16 v[92:95], v[136:139], v[108:111], v[92:95]
  v_mfma_f32_16x16x32_bf16 v[96:99], v[108:111], v[140:143], v[96:99]
Lg_10:
  s_waitcnt lgkmcnt(0)
  s_barrier
  v_mfma_f32_16x16x32_bf16 v[28:31], v[152:155], v[144:147], v[28:31]
  ds_read_b128 v[112:115], v16 offset:32768
  ds_read_b128 v[116:119], v18 offset:32768
  v_mfma_f32_16x16x32_bf16 v[32:35], v[152:155], v[148:151], v[32:35]
  ds_read_b64_tr_b16 v[120:121], v24 offset:40960
  v_mfma_f32_16x16x32_bf16 v[36:39], v[156:159], v[144:147], v[36:39]
  ds_read_b64_tr_b16 v[122:123], v24 offset:41472
  ds_read_b64_tr_b16 v[124:125], v24 offset:49152
  v_mfma_f32_16x16x32_bf16 v[40:43], v[156:159], v[148:151], v[40:43]
  ds_read_b64_tr_b16 v[126:127], v24 offset:49664
  v_mfma_f32_16x16x32_bf16 v[100:103], v[108:111], v[144:147], v[100:103]
  ds_read_b64_tr_b16 v[128:129], v25 offset:57344
  v_mfma_f32_16x16x32_bf16 v[44:47], v[144:147], v[160:163], v[44:47]
  ds_read_b64_tr_b16 v[130:131], v25 offset:57856
  ds_read_b64_tr_b16 v[132:133], v26 offset:40960
  v_mfma_f32_16x16x32_bf16 v[48:51], v[148:151], v[160:163], v[48:51]
  ds_read_b64_tr_b16 v[134:135], v26 offset:41472
  v_mfma_f32_16x16x32_bf16 v[52:55], v[164:167], v[144:147], v[52:55]
  ds_read_b64_tr_b16 v[136:137], v26 offset:49152
  ds_read_b64_tr_b16 v[138:139], v26 offset:49664
  v_mfma_f32_16x16x32_bf16 v[56:59], v[164:167], v[148:151], v[56:59]
  ds_read_b64_tr_b16 v[140:141], v27 offset:57344
  v_mfma_f32_16x16x32_bf16 v[104:107], v[144:147], v[144:147], v[104:107]
  ds_read_b64_tr_b16 v[142:143], v27 offset:57856
  v_mfma_f32_16x16x32_bf16 v[60:63], v[168:171], v[144:147], v[60:63]
  v_mfma_f32_16x16x32_bf16 v[64:67], v[168:171], v[148:151], v[64:67]
  v_mfma_f32_16x16x32_bf16 v[68:71], v[144:147], v[172:175], v[68:71]
  v_mfma_f32_16x16x32_bf16 v[72:75], v[148:151], v[172:175], v[72:75]
  s_cmp_eq_u32 s52, 1
  s_cbranch_scc0 Lg_11
  v_mfma_f32_16x16x32_bf16 v[76:79], v[152:155], v[108:111], v[76:79]
  v_mfma_f32_16x16x32_bf16 v[80:83], v[156:159], v[108:111], v[80:83]
  v_mfma_f32_16x16x32_bf16 v[84:87], v[108:111], v[160:163], v[84:87]
  v_mfma_f32_16x16x32_bf16 v[88:91], v[164:167], v[108:111], v[88:91]
  v_mfma_f32_16x16x32_bf16 v[92:95], v[168:171], v[108:111], v[92:95]
  v_mfma_f32_16x16x32_bf16 v[96:99], v[108:111], v[172:175], v[96:99]
Lg_11:
  s_waitcnt lgkmcnt(0)
  v_mfma_f32_16x16x32_bf16 v[28:31], v[120:123], v[112:115], v[28:31]
  ds_read_b128 v[144:147], v17 offset:32768
  ds_read_b128 v[148:151], v19 offset:32768
  v_mfma_f32_16x16x32_bf16 v[32:35], v[120:123], v[116:119], v[32:35]
  ds_read_b64_tr_b16 v[152:153], v24 offset:45056
  v_mfma_f32_16x16x32_bf16 v[36:39], v[124:127], v[112:115], v[36:39]
  ds_read_b64_tr_b16 v[154:155], v24 offset:45568
  ds_read_b64_tr_b16 v[156:157], v24 offset:53248
  v_mfma_f32_16x16x32_bf16 v[40:43], v[124:127], v[116:119], v[40:43]
  ds_read_b64_tr_b16 v[158:159], v24 offset:53760
  v_mfma_f32_16x16x32_bf16 v[100:103], v[108:111], v[112:115], v[100:103]
  ds_read_b64_tr_b16 v[160:161], v25 offset:61440
  v_mfma_f32_16x16x32_bf16 v[44:47], v[112:115], v[128:131], v[44:47]
  ds_read_b64_tr_b16 v[162:163], v25 offset:61952
  ds_read_b64_tr_b16 v[164:165], v26 offset:45056
  v_mfma_f32_16x16x32_bf16 v[48:51], v[116:119], v[128:131], v[48:51]
  ds_read_b64_tr_b16 v[166:167], v26 offset:45568
  v_mfma_f32_16x16x32_bf16 v[52:55], v[132:135], v[112:115], v[52:55]
  ds_read_b64_tr_b16 v[168:169], v26 offset:53248
  ds_read_b64_tr_b16 v[170:171], v26 offset:53760
  v_mfma_f32_16x16x32_bf16 v[56:59], v[132:135], v[116:119], v[56:59]
  ds_read_b64_tr_b16 v[172:173], v27 offset:61440
  v_mfma_f32_16x16x32_bf16 v[104:107], v[112:115], v[112:115], v[104:107]
  ds_read_b64_tr_b16 v[174:175], v27 offset:61952
  v_mfma_f32_16x16x32_bf16 v[60:63], v[136:139], v[112:115], v[60:63]
  v_mfma_f32_16x16x32_bf16 v[64:67], v[136:139], v[116:119], v[64:67]
  v_mfma_f32_16x16x32_bf16 v[68:71], v[112:115], v[140:143], v[68:71]
  v_mfma_f32_16x16x32_bf16 v[72:75], v[116:119], v[140:143], v[72:75]
  s_cmp_eq_u32 s52, 0
  s_cbranch_scc0 Lg_12
  v_mfma_f32_16x16x32_bf16 v[76:79], v[120:123], v[108:111], v[76:79]
  v_mfma_f32_16x16x32_bf16 v[80:83], v[124:127], v[108:111], v[80:83]
  v_mfma_f32_16x16x32_bf16 v[84:87], v[108:111], v[128:131], v[84:87]
  v_mfma_f32_16x16x32_bf16 v[88:91], v[132:135], v[108:111], v[88:91]
  v_mfma_f32_16x16x32_bf16 v[92:95], v[136:139], v[108:111], v[92:95]
  v_mfma_f32_16x16x32_bf16 v[96:99], v[108:111], v[140:143], v[96:99]
Lg_12:
  v_mov_b32 v6, 0
  global_load_dword v7, v6, s[24:25] sc1
  s_waitcnt lgkmcnt(0)
  s_barrier
  v_mfma_f32_16x16x32_bf16 v[28:31], v[152:155], v[144:147], v[28:31]
  ds_read_b128 v[112:115], v12 offset:0
  ds_read_b128 v[116:119], v14 offset:0
  v_mfma_f32_16x16x32_bf16 v[32:35], v[152:155], v[148:151], v[32:35]
  ds_read_b64_tr_b16 v[120:121], v20 offset:8192
  v_mfma_f32_16x16x32_bf16 v[36:39], v[156:159], v[144:147], v[36:39]
  ds_read_b64_tr_b16 v[122:123], v20 offset:8704
  ds_read_b64_tr_b16 v[124:125], v20 offset:16384
  v_mfma_f32_16x16x32_bf16 v[40:43], v[156:159], v[148:151], v[40:43]
  ds_read_b64_tr_b16 v[126:127], v20 offset:16896
  v_mfma_f32_16x16x32_bf16 v[100:103], v[108:111], v[144:147], v[100:103]
  ds_read_b64_tr_b16 v[128:129], v21 offset:24576
  v_mfma_f32_16x16x32_bf16 v[44:47], v[144:147], v[160:163], v[44:47]
  ds_read_b64_tr_b16 v[130:131], v21 offset:25088
  ds_read_b64_tr_b16 v[132:133], v22 offset:8192
  v_mfma_f32_16x16x32_bf16 v[48:51], v[148:151], v[160:163], v[48:51]
  ds_read_b64_tr_b16 v[134:135], v22 offset:8704
  v_mfma_f32_16x16x32_bf16 v[52:55], v[164:167], v[144:147], v[52:55]
  ds_read_b64_tr_b16 v[136:137], v22 offset:16384
  ds_read_b64_tr_b16 v[138:139], v22 offset:16896
  v_mfma_f32_16x16x32_bf16 v[56:59], v[164:167], v[148:151], v[56:59]
  ds_read_b64_tr_b16 v[140:141], v23 offset:24576
  v_mfma_f32_16x16x32_bf16 v[104:107], v[144:147], v[144:147], v[104:107]
  ds_read_b64_tr_b16 v[142:143], v23 offset:25088
  v_mfma_f32_16x16x32_bf16 v[60:63], v[168:171], v[144:147], v[60:63]
  v_mfma_f32_16x16x32_bf16 v[64:67], v[168:171], v[148:151], v[64:67]
  v_mfma_f32_16x16x32_bf16 v[68:71], v[144:147], v[172:175], v[68:71]
  v_mfma_f32_16x16x32_bf16 v[72:75], v[148:151], v[172:175], v[72:75]
  s_cmp_eq_u32 s52, 1
  s_cbranch_scc0 Lg_13
  v_mfma_f32_16x16x32_bf16 v[76:79], v[152:155], v[108:111], v[76:79]
  v_mfma_f32_16x16x32_bf16 v[80:83], v[156:159], v[108:111], v[80:83]
  v_mfma_f32_16x16x32_bf16 v[84:87], v[108:111], v[160:163], v[84:87]
  v_mfma_f32_16x16x32_bf16 v[88:91], v[164:167], v[108:111], v[88:91]
  v_mfma_f32_16x16x32_bf16 v[92:95], v[168:171], v[108:111], v[92:95]
  v_mfma_f32_16x16x32_bf16 v[96:99], v[108:111], v[172:175], v[96:99]
Lg_13:
  s_waitcnt lgkmcnt(0)
  v_mfma_f32_16x16x32_bf16 v[28:31], v[120:123], v[112:115], v[28:31]
  ds_read_b128 v[144:147], v13 offset:0
  ds_read_b128 v[148:151], v15 offset:0
  v_mfma_f32_16x16x32_bf16 v[32:35], v[120:123], v[116:119], v[32:35]
  ds_read_b64_tr_b16 v[152:153], v20 offset:12288
  v_mfma_f32_16x16x32_bf16 v[36:39], v[124:127], v[112:115], v[36:39]
  ds_read_b64_tr_b16 v[154:155], v20 offset:12800
  ds_read_b64_tr_b16 v[156:157], v20 offset:20480
  v_mfma_f32_16x16x32_bf16 v[40:43], v[124:127], v[116:119], v[40:43]
  ds_read_b64_tr_b16 v[158:159], v20 offset:20992
  v_mfma_f32_16x16x32_bf16 v[100:103], v[108:111], v[112:115], v[100:103]
  ds_read_b64_tr_b16 v[160:161], v21 offset:28672
  v_mfma_f32_16x16x32_bf16 v[44:47], v[112:115], v[128:131], v[44:47]
  ds_read_b64_tr_b16 v[162:163], v21 offset:29184
  ds_read_b64_tr_b16 v[164:165], v22 offset:12288
  v_mfma_f32_16x16x32_bf16 v[48:51], v[116:119], v[128:131], v[48:51]
  ds_read_b64_tr_b16 v[166:167], v22 offset:12800
  v_mfma_f32_16x16x32_bf16 v[52:55], v[132:135], v[112:115], v[52:55]
  ds_read_b64_tr_b16 v[168:169], v22 offset:20480
  ds_read_b64_tr_b16 v[170:171], v22 offset:20992
  v_mfma_f32_16x16x32_bf16 v[56:59], v[132:135], v[116:119], v[56:59]
  ds_read_b64_tr_b16 v[172:173], v23 offset:28672
  v_mfma_f32_16x16x32_bf16 v[104:107], v[112:115], v[112:115], v[104:107]
  ds_read_b64_tr_b16 v[174:175], v23 offset:29184
  v_mfma_f32_16x16x32_bf16 v[60:63], v[136:139], v[112:115], v[60:63]
  v_mfma_f32_16x16x32_bf16 v[64:67], v[136:139], v[116:119], v[64:67]
  v_mfma_f32_16x16x32_bf16 v[68:71], v[112:115], v[140:143], v[68:71]
  v_mfma_f32_16x16x32_bf16 v[72:75], v[116:119], v[140:143], v[72:75]
  s_cmp_eq_u32 s52, 0
  s_cbranch_scc0 Lg_14
  v_mfma_f32_16x16x32_bf16 v[76:79], v[120:123], v[108:111], v[76:79]
  v_mfma_f32_16x16x32_bf16 v[80:83], v[124:127], v[108:111], v[80:83]
  v_mfma_f32_16x16x32_bf16 v[84:87], v[108:111], v[128:131], v[84:87]
  v_mfma_f32_16x16x32_bf16 v[88:91], v[132:135], v[108:111], v[88:91]
  v_mfma_f32_16x16x32_bf16 v[92:95], v[136:139], v[108:111], v[92:95]
  v_mfma_f32_16x16x32_bf16 v[96:99], v[108:111], v[140:143], v[96:99]
Lg_14:
  s_waitcnt lgkmcnt(0)
  s_barrier
  v_mfma_f32_16x16x32_bf16 v[28:31], v[152:155], v[144:147], v[28:31]
  ds_read_b128 v[112:115], v12 offset:32768
  ds_read_b128 v[116:119], v14 offset:32768
  v_mfma_f32_16x16x32_bf16 v[32:35], v[152:155], v[148:151], v[32:35]
  ds_read_b64_tr_b16 v[120:121], v20 offset:40960
  v_mfma_f32_16x16x32_bf16 v[36:39], v[156:159], v[144:147], v[36:39]
  ds_read_b64_tr_b16 v[122:123], v20 offset:41472
  ds_read_b64_tr_b16 v[124:125], v20 offset:49152
  v_mfma_f32_16x16x32_bf16 v[40:43], v[156:159], v[148:151], v[40:43]
  ds_read_b64_tr_b16 v[126:127], v20 offset:49664
  v_mfma_f32_16x16x32_bf16 v[100:103], v[108:111], v[144:147], v[100:103]
  ds_read_b64_tr_b16 v[128:129], v21 offset:57344
  v_mfma_f32_16x16x32_bf16 v[44:47], v[144:147], v[160:163], v[44:47]
  ds_read_b64_tr_b16 v[130:131], v21 offset:57856
  ds_read_b64_tr_b16 v[132:133], v22 offset:40960
  v_mfma_f32_16x16x32_bf16 v[48:51], v[148:151], v[160:163], v[48:51]
  ds_read_b64_tr_b16 v[134:135], v22 offset:41472
  v_mfma_f32_16x16x32_bf16 v[52:55], v[164:167], v[144:147], v[52:55]
  ds_read_b64_tr_b16 v[136:137], v22 offset:49152
  ds_read_b64_tr_b16 v[138:139], v22 offset:49664
  v_mfma_f32_16x16x32_bf16 v[56:59], v[164:167], v[148:151], v[56:59]
  ds_read_b64_tr_b16 v[140:141], v23 offset:57344
  v_mfma_f32_16x16x32_bf16 v[104:107], v[144:147], v[144:147], v[104:107]
  ds_read_b64_tr_b16 v[142:143], v23 offset:57856
  v_mfma_f32_16x16x32_bf16 v[60:63], v[168:171], v[144:147], v[60:63]
  v_mfma_f32_16x16x32_bf16 v[64:67], v[168:171], v[148:151], v[64:67]
  v_mfma_f32_16x16x32_bf16 v[68:71], v[144:147], v[172:175], v[68:71]
  v_mfma_f32_16x16x32_bf16 v[72:75], v[148:151], v[172:175], v[72:75]
  s_cmp_eq_u32 s52, 1
  s_cbranch_scc0 Lg_15
  v_mfma_f32_16x16x32_bf16 v[76:79], v[152:155], v[108:111], v[76:79]
  v_mfma_f32_16x16x32_bf16 v[80:83], v[156:159], v[108:111], v[80:83]
  v_mfma_f32_16x16x32_bf16 v[84:87], v[108:111], v[160:163], v[84:87]
  v_mfma_f32_16x16x32_bf16 v[88:91], v[164:167], v[108:111], v[88:91]
  v_mfma_f32_16x16x32_bf16 v[92:95], v[168:171], v[108:111], v[92:95]
  v_mfma_f32_16x16x32_bf16 v[96:99], v[108:111], v[172:175], v[96:99]
Lg_15:
  s_waitcnt lgkmcnt(0)
  v_mfma_f32_16x16x32_bf16 v[28:31], v[120:123], v[112:115], v[28:31]
  ds_read_b128 v[144:147], v13 offset:32768
  ds_read_b128 v[148:151], v15 offset:32768
  v_mfma_f32_16x16x32_bf16 v[32:35], v[120:123], v[116:119], v[32:35]
  ds_read_b64_tr_b16 v[152:153], v20 offset:45056
  v_mfma_f32_16x16x32_bf16 v[36:39], v[124:127], v[112:115], v[36:39]
  ds_read_b64_tr_b16 v[154:155], v20 offset:45568
  ds_read_b64_tr_b16 v[156:157], v20 offset:53248
  v_mfma_f32_16x16x32_bf16 v[40:43], v[124:127], v[116:119], v[40:43]
  ds_read_b64_tr_b16 v[158:159], v20 offset:53760
  v_mfma_f32_16x16x32_bf16 v[100:103], v[108:111], v[112:115], v[100:103]
  ds_read_b64_tr_b16 v[160:161], v21 offset:61440
  v_mfma_f32_16x16x32_bf16 v[44:47], v[112:115], v[128:131], v[44:47]
  ds_read_b64_tr_b16 v[162:163], v21 offset:61952
  ds_read_b64_tr_b16 v[164:165], v22 offset:45056
  v_mfma_f32_16x16x32_bf16 v[48:51], v[116:119], v[128:131], v[48:51]
  ds_read_b64_tr_b16 v[166:167], v22 offset:45568
  v_mfma_f32_16x16x32_bf16 v[52:55], v[132:135], v[112:115], v[52:55]
  ds_read_b64_tr_b16 v[168:169], v22 offset:53248
  ds_read_b64_tr_b16 v[170:171], v22 offset:53760
  v_mfma_f32_16x16x32_bf16 v[56:59], v[132:135], v[116:119], v[56:59]
  ds_read_b64_tr_b16 v[172:173], v23 offset:61440
  v_mfma_f32_16x16x32_bf16 v[104:107], v[112:115], v[112:115], v[104:107]
  ds_read_b64_tr_b16 v[174:175], v23 offset:61952
  v_mfma_f32_16x16x32_bf16 v[60:63], v[136:139], v[112:115], v[60:63]
  v_mfma_f32_16x16x32_bf16 v[64:67], v[136:139], v[116:119], v[64:67]
  v_mfma_f32_16x16x32_bf16 v[68:71], v[112:115], v[140:143], v[68:71]
  v_mfma_f32_16x16x32_bf16 v[72:75], v[116:119], v[140:143], v[72:75]
  s_cmp_eq_u32 s52, 0
  s_cbranch_scc0 Lg_16
  v_mfma_f32_16x16x32_bf16 v[76:79], v[120:123], v[108:111], v[76:79]
  v_mfma_f32_16x16x32_bf16 v[80:83], v[124:127], v[108:111], v[80:83]
  v_mfma_f32_16x16x32_bf16 v[84:87], v[108:111], v[128:131], v[84:87]
  v_mfma_f32_16x16x32_bf16 v[88:91], v[132:135], v[108:111], v[88:91]
  v_mfma_f32_16x16x32_bf16 v[92:95], v[136:139], v[108:111], v[92:95]
  v_mfma_f32_16x16x32_bf16 v[96:99], v[108:111], v[140:143], v[96:99]
Lg_16:
  s_waitcnt lgkmcnt(0)
  s_barrier
  v_mfma_f32_16x16x32_bf16 v[28:31], v[152:155], v[144:147], v[28:31]
  ds_read_b128 v[112:115], v16 offset:0
  ds_read_b128 v[116:119], v18 offset:0
  v_mfma_f32_16x16x32_bf16 v[32:35], v[152:155], v[148:151], v[32:35]
  ds_read_b64_tr_b16 v[120:121], v24 offset:8192
  v_mfma_f32_16x16x32_bf16 v[36:39], v[156:159], v[144:147], v[36:39]
  ds_read_b64_tr_b16 v[122:123], v24 offset:8704
  ds_read_b64_tr_b16 v[124:125], v24 offset:16384
  v_mfma_f32_16x16x32_bf16 v[40:43], v[156:159], v[148:151], v[40:43]
  ds_read_b64_tr_b16 v[126:127], v24 offset:16896
  v_mfma_f32_16x16x32_bf16 v[100:103], v[108:111], v[144:147], v[100:103]
  ds_read_b64_tr_b16 v[128:129], v25 offset:24576
  v_mfma_f32_16x16x32_bf16 v[44:47], v[144:147], v[160:163], v[44:47]
  ds_read_b64_tr_b16 v[130:131], v25 offset:25088
  ds_read_b64_tr_b16 v[132:133], v26 offset:8192
  v_mfma_f32_16x16x32_bf16 v[48:51], v[148:151], v[160:163], v[48:51]
  ds_read_b64_tr_b16 v[134:135], v26 offset:8704
  v_mfma_f32_16x16x32_bf16 v[52:55], v[164:167], v[144:147], v[52:55]
  ds_read_b64_tr_b16 v[136:137], v26 offset:16384
  ds_read_b64_tr_b16 v[138:139], v26 offset:16896
  v_mfma_f32_16x16x32_bf16 v[56:59], v[164:167], v[148:151], v[56:59]
  ds_read_b64_tr_b16 v[140:141], v27 offset:24576
  v_mfma_f32_16x16x32_bf16 v[104:107], v[144:147], v[144:147], v[104:107]
  ds_read_b64_tr_b16 v[142:143], v27 offset:25088
  v_mfma_f32_16x16x32_bf16 v[60:63], v[168:171], v[144:147], v[60:63]
  v_mfma_f32_16x16x32_bf16 v[64:67], v[168:171], v[148:151], v[64:67]
  v_mfma_f32_16x16x32_bf16 v[68:71], v[144:147], v[172:175], v[68:71]
  v_mfma_f32_16x16x32_bf16 v[72:75], v[148:151], v[172:175], v[72:75]
  s_cmp_eq_u32 s52, 1
  s_cbranch_scc0 Lg_17
  v_mfma_f32_16x16x32_bf16 v[76:79], v[152:155], v[108:111], v[76:79]
  v_mfma_f32_16x16x32_bf16 v[80:83], v[156:159], v[108:111], v[80:83]
  v_mfma_f32_16x16x32_bf16 v[84:87], v[108:111], v[160:163], v[84:87]
  v_mfma_f32_16x16x32_bf16 v[88:91], v[164:167], v[108:111], v[88:91]
  v_mfma_f32_16x16x32_bf16 v[92:95], v[168:171], v[108:111], v[92:95]
  v_mfma_f32_16x16x32_bf16 v[96:99], v[108:111], v[172:175], v[96:99]
Lg_17:
  s_waitcnt lgkmcnt(0)
  v_mfma_f32_16x16x32_bf16 v[28:31], v[120:123], v[112:115], v[28:31]
  ds_read_b128 v[144:147], v17 offset:0
  ds_read_b128 v[148:151], v19 offset:0
  v_mfma_f32_16x16x32_bf16 v[32:35], v[120:123], v[116:119], v[32:35]
  ds_read_b64_tr_b16 v[152:153], v24 offset:12288
  v_mfma_f32_16x16x32_bf16 v[36:39], v[124:127], v[112:115], v[36:39]
  ds_read_b64_tr_b16 v[154:155], v24 offset:12800
  ds_read_b64_tr_b16 v[156:157], v24 offset:20480
  v_mfma_f32_16x16x32_bf16 v[40:43], v[124:127], v[116:119], v[40:43]
  ds_read_b64_tr_b16 v[158:159], v24 offset:20992
  v_mfma_f32_16x16x32_bf16 v[100:103], v[108:111], v[112:115], v[100:103]
  ds_read_b64_tr_b16 v[160:161], v25 offset:28672
  v_mfma_f32_16x16x32_bf16 v[44:47], v[112:115], v[128:131], v[44:47]
  ds_read_b64_tr_b16 v[162:163], v25 offset:29184
  ds_read_b64_tr_b16 v[164:165], v26 offset:12288
  v_mfma_f32_16x16x32_bf16 v[48:51], v[116:119], v[128:131], v[48:51]
  ds_read_b64_tr_b16 v[166:167], v26 offset:12800
  v_mfma_f32_16x16x32_bf16 v[52:55], v[132:135], v[112:115], v[52:55]
  ds_read_b64_tr_b16 v[168:169], v26 offset:20480
  ds_read_b64_tr_b16 v[170:171], v26 offset:20992
  v_mfma_f32_16x16x32_bf16 v[56:59], v[132:135], v[116:119], v[56:59]
  ds_read_b64_tr_b16 v[172:173], v27 offset:28672
  v_mfma_f32_16x16x32_bf16 v[104:107], v[112:115], v[112:115], v[104:107]
  ds_read_b64_tr_b16 v[174:175], v27 offset:29184
  v_mfma_f32_16x16x32_bf16 v[60:63], v[136:139], v[112:115], v[60:63]
  v_mfma_f32_16x16x32_bf16 v[64:67], v[136:139], v[116:119], v[64:67]
  v_mfma_f32_16x16x32_bf16 v[68:71], v[112:115], v[140:143], v[68:71]
  v_mfma_f32_16x16x32_bf16 v[72:75], v[116:119], v[140:143], v[72:75]
  s_cmp_eq_u32 s52, 0
  s_cbranch_scc0 Lg_18
  v_mfma_f32_16x16x32_bf16 v[76:79], v[120:123], v[108:111], v[76:79]
  v_mfma_f32_16x16x32_bf16 v[80:83], v[124:127], v[108:111], v[80:83]
  v_mfma_f32_16x16x32_bf16 v[84:87], v[108:111], v[128:131], v[84:87]
  v_mfma_f32_16x16x32_bf16 v[88:91], v[132:135], v[108:111], v[88:91]
  v_mfma_f32_16x16x32_bf16 v[92:95], v[136:139], v[108:111], v[92:95]
  v_mfma_f32_16x16x32_bf16 v[96:99], v[108:111], v[140:143], v[96:99]
Lg_18:
  s_waitcnt lgkmcnt(0)
  s_barrier
  v_mfma_f32_16x16x32_bf16 v[28:31], v[152:155], v[144:147], v[28:31]
  ds_read_b128 v[112:115], v16 offset:32768
  ds_read_b128 v[116:119], v18 offset:32768
  v_mfma_f32_16x16x32_bf16 v[32:35], v[152:155], v[148:151], v[32:35]
  ds_read_b64_tr_b16 v[120:121], v24 offset:40960
  v_mfma_f32_16x16x32_bf16 v[36:39], v[156:159], v[144:147], v[36:39]
  ds_read_b64_tr_b16 v[122:123], v24 offset:41472
  ds_read_b64_tr_b16 v[124:125], v24 offset:49152
  v_mfma_f32_16x16x32_bf16 v[40:43], v[156:159], v[148:151], v[40:43]
  ds_read_b64_tr_b16 v[126:127], v24 offset:49664
  v_mfma_f32_16x16x32_bf16 v[100:103], v[108:111], v[144:147], v[100:103]
  ds_read_b64_tr_b16 v[128:129], v25 offset:57344
  v_mfma_f32_16x16x32_bf16 v[44:47], v[144:147], v[160:163], v[44:47]
  ds_read_b64_tr_b16 v[130:131], v25 offset:57856
  ds_read_b64_tr_b16 v[132:133], v26 offset:40960
  v_mfma_f32_16x16x32_bf16 v[48:51], v[148:151], v[160:163], v[48:51]
  ds_read_b64_tr_b16 v[134:135], v26 offset:41472
  v_mfma_f32_16x16x32_bf16 v[52:55], v[164:167], v[144:147], v[52:55]
  ds_read_b64_tr_b16 v[136:137], v26 offset:49152
  ds_read_b64_tr_b16 v[138:139], v26 offset:49664
  v_mfma_f32_16x16x32_bf16 v[56:59], v[164:167], v[148:151], v[56:59]
  ds_read_b64_tr_b16 v[140:141], v27 offset:57344
  v_mfma_f32_16x16x32_bf16 v[104:107], v[144:147], v[144:147], v[104:107]
  ds_read_b64_tr_b16 v[142:143], v27 offset:57856
  v_mfma_f32_16x16x32_bf16 v[60:63], v[168:171], v[144:147], v[60:63]
  v_mfma_f32_16x16x32_bf16 v[64:67], v[168:171], v[148:151], v[64:67]
  v_mfma_f32_16x16x32_bf16 v[68:71], v[144:147], v[172:175], v[68:71]
  v_mfma_f32_16x16x32_bf16 v[72:75], v[148:151], v[172:175], v[72:75]
  s_cmp_eq_u32 s52, 1
  s_cbranch_scc0 Lg_19
  v_mfma_f32_16x16x32_bf16 v[76:79], v[152:155], v[108:111], v[76:79]
  v_mfma_f32_16x16x32_bf16 v[80:83], v[156:159], v[108:111], v[80:83]
  v_mfma_f32_16x16x32_bf16 v[84:87], v[108:111], v[160:163], v[84:87]
  v_mfma_f32_16x16x32_bf16 v[88:91], v[164:167], v[108:111], v[88:91]
  v_mfma_f32_16x16x32_bf16 v[92:95], v[168:171], v[108:111], v[92:95]
  v_mfma_f32_16x16x32_bf16 v[96:99], v[108:111], v[172:175], v[96:99]
Lg_19:
  s_waitcnt lgkmcnt(0)
  v_mfma_f32_16x16x32_bf16 v[28:31], v[120:123], v[112:115], v[28:31]
  ds_read_b128 v[144:147], v17 offset:32768
  ds_read_b128 v[148:151], v19 offset:32768
  v_mfma_f32_16x16x32_bf16 v[32:35], v[120:123], v[116:119], v[32:35]
  ds_read_b64_tr_b16 v[152:153], v24 offset:45056
  v_mfma_f32_16x16x32_bf16 v[36:39], v[124:127], v[112:115], v[36:39]
  ds_read_b64_tr_b16 v[154:155], v24 offset:45568
  ds_read_b64_tr_b16 v[156:157], v24 offset:53248
  v_mfma_f32_16x16x32_bf16 v[40:43], v[124:127], v[116:119], v[40:43]
  ds_read_b64_tr_b16 v[158:159], v24 offset:53760
  v_mfma_f32_16x16x32_bf16 v[100:103], v[108:111], v[112:115], v[100:103]
  ds_read_b64_tr_b16 v[160:161], v25 offset:61440
  v_mfma_f32_16x16x32_bf16 v[44:47], v[112:115], v[128:131], v[44:47]
  ds_read_b64_tr_b16 v[162:163], v25 offset:61952
  ds_read_b64_tr_b16 v[164:165], v26 offset:45056
  v_mfma_f32_16x16x32_bf16 v[48:51], v[116:119], v[128:131], v[48:51]
  ds_read_b64_tr_b16 v[166:167], v26 offset:45568
  v_mfma_f32_16x16x32_bf16 v[52:55], v[132:135], v[112:115], v[52:55]
  ds_read_b64_tr_b16 v[168:169], v26 offset:53248
  ds_read_b64_tr_b16 v[170:171], v26 offset:53760
  v_mfma_f32_16x16x32_bf16 v[56:59], v[132:135], v[116:119], v[56:59]
  ds_read_b64_tr_b16 v[172:173], v27 offset:61440
  v_mfma_f32_16x16x32_bf16 v[104:107], v[112:115], v[112:115], v[104:107]
  ds_read_b64_tr_b16 v[174:175], v27 offset:61952
  v_mfma_f32_16x16x32_bf16 v[60:63], v[136:139], v[112:115], v[60:63]
  v_mfma_f32_16x16x32_bf16 v[64:67], v[136:139], v[116:119], v[64:67]
  v_mfma_f32_16x16x32_bf16 v[68:71], v[112:115], v[140:143], v[68:71]
  v_mfma_f32_16x16x32_bf16 v[72:75], v[116:119], v[140:143], v[72:75]
  s_cmp_eq_u32 s52, 0
  s_cbranch_scc0 Lg_20
  v_mfma_f32_16x16x32_bf16 v[76:79], v[120:123], v[108:111], v[76:79]
  v_mfma_f32_16x16x32_bf16 v[80:83], v[124:127], v[108:111], v[80:83]
  v_mfma_f32_16x16x32_bf16 v[84:87], v[108:111], v[128:131], v[84:87]
  v_mfma_f32_16x16x32_bf16 v[88:91], v[132:135], v[108:111], v[88:91]
  v_mfma_f32_16x16x32_bf16 v[92:95], v[136:139], v[108:111], v[92:95]
  v_mfma_f32_16x16x32_bf16 v[96:99], v[108:111], v[140:143], v[96:99]
Lg_20:
  s_waitcnt lgkmcnt(0)
  v_mfma_f32_16x16x32_bf16 v[28:31], v[152:155], v[144:147], v[28:31]
  v_mfma_f32_16x16x32_bf16 v[32:35], v[152:155], v[148:151], v[32:35]
  v_mfma_f32_16x16x32_bf16 v[36:39], v[156:159], v[144:147], v[36:39]
  v_mfma_f32_16x16x32_bf16 v[40:43], v[156:159], v[148:151], v[40:43]
  v_mfma_f32_16x16x32_bf16 v[100:103], v[108:111], v[144:147], v[100:103]
  v_mfma_f32_16x16x32_bf16 v[44:47], v[144:147], v[160:163], v[44:47]
  v_mfma_f32_16x16x32_bf16 v[48:51], v[148:151], v[160:163], v[48:51]
  v_mfma_f32_16x16x32_bf16 v[52:55], v[164:167], v[144:147], v[52:55]
  v_mfma_f32_16x16x32_bf16 v[56:59], v[164:167], v[148:151], v[56:59]
  v_mfma_f32_16x16x32_bf16 v[104:107], v[144:147], v[144:147], v[104:107]
  v_mfma_f32_16x16x32_bf16 v[60:63], v[168:171], v[144:147], v[60:63]
  v_mfma_f32_16x16x32_bf16 v[64:67], v[168:171], v[148:151], v[64:67]
  v_mfma_f32_16x16x32_bf16 v[68:71], v[144:147], v[172:175], v[68:71]
  v_mfma_f32_16x16x32_bf16 v[72:75], v[148:151], v[172:175], v[72:75]
  s_cmp_eq_u32 s52, 1
  s_cbranch_scc0 Lg_21
  v_mfma_f32_16x16x32_bf16 v[76:79], v[152:155], v[108:111], v[76:79]
  v_mfma_f32_16x16x32_bf16 v[80:83], v[156:159], v[108:111], v[80:83]
  v_mfma_f32_16x16x32_bf16 v[84:87], v[108:111], v[160:163], v[84:87]
  v_mfma_f32_16x16x32_bf16 v[88:91], v[164:167], v[108:111], v[88:91]
  v_mfma_f32_16x16x32_bf16 v[92:95], v[168:171], v[108:111], v[92:95]
  v_mfma_f32_16x16x32_bf16 v[96:99], v[108:111], v[172:175], v[96:99]
Lg_21:
  s_waitcnt vmcnt(0)
  v_readfirstlane_b32 s4, v7
  s_cmp_lg_u32 s4, 0
  s_cbranch_scc1 Lnn_22
  s_mov_b32 s3, 0
  v_mov_b32 v3, 0
Lp_23:
  global_load_dword v2, v3, s[24:25] sc1
  s_waitcnt vmcnt(0)
  v_readfirstlane_b32 s4, v2
  s_cmp_lg_u32 s4, 0
  s_cbranch_scc1 Lo_24
  s_add_u32 s3, s3, 1
  s_cmp_lt_u32 s3, 400000
  s_cbranch_scc1 Lp_23
Lo_24:
Lnn_22:
  v_cmp_eq_u32 vcc, 1, v184
  s_nop 1
  v_cndmask_b32 v6, v104, v105, vcc
  v_cmp_eq_u32 vcc, 2, v184
  s_nop 1
  v_cndmask_b32 v6, v6, v106, vcc
  v_cmp_eq_u32 vcc, 3, v184
  s_nop 1
  v_cndmask_b32 v6, v6, v107, vcc
  v_cmp_eq_u32 vcc, 0, v185
  s_nop 1
  v_cndmask_b32 v101, 0, v6, vcc
  ds_write_b128 v188, v[76:79] offset:1024
  ds_write_b128 v188, v[80:83] offset:1088
  ds_write_b32 v189, v84 offset:1152
  ds_write_b128 v188, v[88:91] offset:1216
  ds_write_b128 v188, v[92:95] offset:1280
  ds_write_b32 v189, v96 offset:1344
  v_mov_b32 v7, v101
  s_nop 1
  v_permlane32_swap_b32 v101, v7
  v_add_f32 v101, v101, v7
  v_mov_b32 v7, v101
  s_nop 1
  v_permlane16_swap_b32 v101, v7
  v_add_f32 v101, v101, v7
  v_mul_f32 v100, 0x3b000000, v100
  v_mul_f32 v7, v100, v100
  v_mov_b32 v112, 0x3b000000
  v_fma_f32 v7, v101, v112, -v7
  v_max_f32 v7, 0, v7
  v_add_f32 v7, 0x3727c5ac, v7
  v_rsq_f32 v112, v7
  s_nop 0
  v_mul_f32 v113, v100, v112
  v_sub_f32 v113, 0, v113
  ds_write_b32 v186, v112
  ds_write_b32 v186, v113 offset:256
  s_waitcnt lgkmcnt(0)
  s_barrier
  ds_read_b32 v114, v187
  ds_read_b32 v115, v187 offset:256
  ds_read_b128 v[120:123], v190 offset:1024
  ds_read_b128 v[124:127], v190 offset:1088
  ds_read_b32 v128, v191 offset:1152
  ds_read_b128 v[132:135], v190 offset:1216
  ds_read_b128 v[136:139], v190 offset:1280
  ds_read_b32 v140, v191 offset:1344
  ds_read_b128 v[152:155], v193
  ds_read_b128 v[156:159], v193 offset:256
  ds_read_b128 v[144:147], v192
  ds_read_b128 v[148:151], v192 offset:256
  s_waitcnt lgkmcnt(0)
  v_pk_add_f32 v[76:77], v[76:77], v[120:121]
  v_pk_add_f32 v[78:79], v[78:79], v[122:123]
  v_pk_add_f32 v[80:81], v[80:81], v[124:125]
  v_pk_add_f32 v[82:83], v[82:83], v[126:127]
  v_add_f32 v84, v84, v128
  v_pk_add_f32 v[88:89], v[88:89], v[132:133]
  v_pk_add_f32 v[90:91], v[90:91], v[134:135]
  v_pk_add_f32 v[92:93], v[92:93], v[136:137]
  v_pk_add_f32 v[94:95], v[94:95], v[138:139]
  v_add_f32 v96, v96, v140
  v_mul_f32 v116, 0x3eb8aa3b, v112
  v_mul_f32 v117, 0x3eb8aa3b, v113
  v_mul_f32 v118, 0x3eb8aa3b, v114
  v_mul_f32 v119, 0x3eb8aa3b, v115
  v_pk_mul_f32 v[160:161], v[80:81], v[112:113] op_sel:[0,1] op_sel_hi:[1,1]
  v_pk_mul_f32 v[162:163], v[82:83], v[112:113] op_sel:[0,1] op_sel_hi:[1,1]
  v_pk_mul_f32 v[164:165], v[80:81], v[114:115] op_sel:[0,1] op_sel_hi:[1,1]
  v_pk_mul_f32 v[166:167], v[82:83], v[114:115] op_sel:[0,1] op_sel_hi:[1,1]
  v_pk_mul_f32 v[168:169], v[92:93], v[112:113] op_sel:[0,1] op_sel_hi:[1,1]
  v_pk_mul_f32 v[170:171], v[94:95], v[112:113] op_sel:[0,1] op_sel_hi:[1,1]
  v_pk_mul_f32 v[172:173], v[92:93], v[114:115] op_sel:[0,1] op_sel_hi:[1,1]
  v_pk_mul_f32 v[174:175], v[94:95], v[114:115] op_sel:[0,1] op_sel_hi:[1,1]
  v_pk_mul_f32 v[176:177], v[148:149], v[84:85] op_sel_hi:[1,0]
  v_pk_mul_f32 v[178:179], v[150:151], v[84:85] op_sel_hi:[1,0]
  v_pk_mul_f32 v[180:181], v[156:157], v[84:85] op_sel_hi:[1,0]
  v_pk_mul_f32 v[182:183], v[158:159], v[84:85] op_sel_hi:[1,0]
  v_pk_fma_f32 v[36:37], v[36:37], v[112:113], v[160:161] op_sel_hi:[1,0,1]
  v_pk_fma_f32 v[38:39], v[38:39], v[112:113], v[162:163] op_sel_hi:[1,0,1]
  v_pk_fma_f32 v[40:41], v[40:41], v[114:115], v[164:165] op_sel_hi:[1,0,1]
  v_pk_fma_f32 v[42:43], v[42:43], v[114:115], v[166:167] op_sel_hi:[1,0,1]
  v_pk_fma_f32 v[60:61], v[60:61], v[112:113], v[168:169] op_sel_hi:[1,0,1]
  v_pk_fma_f32 v[62:63], v[62:63], v[112:113], v[170:171] op_sel_hi:[1,0,1]
  v_pk_fma_f32 v[64:65], v[64:65], v[114:115], v[172:173] op_sel_hi:[1,0,1]
  v_pk_fma_f32 v[66:67], v[66:67], v[114:115], v[174:175] op_sel_hi:[1,0,1]
  v_pk_fma_f32 v[44:45], v[44:45], v[144:145], v[176:177]
  v_pk_fma_f32 v[46:47], v[46:47], v[146:147], v[178:179]
  v_pk_fma_f32 v[48:49], v[48:49], v[152:153], v[180:181]
  v_pk_fma_f32 v[50:51], v[50:51], v[154:155], v[182:183]
  v_cvt_pk_bf16_f32 v160, v36, v37
  v_cvt_pk_bf16_f32 v161, v38, v39
  buffer_store_dwordx2 v[160:161], v194, s[36:39], s65 offen sc1
  v_cvt_pk_bf16_f32 v164, v40, v41
  v_cvt_pk_bf16_f32 v165, v42, v43
  buffer_store_dwordx2 v[164:165], v195, s[36:39], s65 offen sc1
  v_cvt_pk_bf16_f32 v168, v60, v61
  v_cvt_pk_bf16_f32 v169, v62, v63
  buffer_store_dwordx2 v[168:169], v194, s[36:39], s68 offen sc1
  v_cvt_pk_bf16_f32 v172, v64, v65
  v_cvt_pk_bf16_f32 v173, v66, v67
  buffer_store_dwordx2 v[172:173], v195, s[36:39], s68 offen sc1
  v_cvt_pk_bf16_f32 v176, v44, v45
  v_cvt_pk_bf16_f32 v177, v46, v47
  buffer_store_dwordx2 v[176:177], v196, s[36:39], s66 offen sc1
  v_cvt_pk_bf16_f32 v180, v48, v49
  v_cvt_pk_bf16_f32 v181, v50, v51
  buffer_store_dwordx2 v[180:181], v197, s[36:39], s66 offen sc1
  v_pk_mul_f32 v[160:161], v[148:149], v[96:97] op_sel_hi:[1,0]
  v_pk_mul_f32 v[162:163], v[150:151], v[96:97] op_sel_hi:[1,0]
  v_pk_mul_f32 v[164:165], v[156:157], v[96:97] op_sel_hi:[1,0]
  v_pk_mul_f32 v[166:167], v[158:159], v[96:97] op_sel_hi:[1,0]
  v_pk_mul_f32 v[168:169], v[76:77], v[116:117] op_sel:[0,1] op_sel_hi:[1,1]
  v_pk_mul_f32 v[170:171], v[78:79], v[116:117] op_sel:[0,1] op_sel_hi:[1,1]
  v_pk_mul_f32 v[172:173], v[76:77], v[118:119] op_sel:[0,1] op_sel_hi:[1,1]
  v_pk_mul_f32 v[174:175], v[78:79], v[118:119] op_sel:[0,1] op_sel_hi:[1,1]
  v_pk_mul_f32 v[176:177], v[88:89], v[116:117] op_sel:[0,1] op_sel_hi:[1,1]
  v_pk_mul_f32 v[178:179], v[90:91], v[116:117] op_sel:[0,1] op_sel_hi:[1,1]
  v_pk_mul_f32 v[180:181], v[88:89], v[118:119] op_sel:[0,1] op_sel_hi:[1,1]
  v_pk_mul_f32 v[182:183], v[90:91], v[118:119] op_sel:[0,1] op_sel_hi:[1,1]
  v_pk_fma_f32 v[68:69], v[68:69], v[144:145], v[160:161]
  v_pk_fma_f32 v[70:71], v[70:71], v[146:147], v[162:163]
  v_pk_fma_f32 v[72:73], v[72:73], v[152:153], v[164:165]
  v_pk_fma_f32 v[74:75], v[74:75], v[154:155], v[166:167]
  v_pk_fma_f32 v[28:29], v[28:29], v[116:117], v[168:169] op_sel_hi:[1,0,1]
  v_pk_fma_f32 v[30:31], v[30:31], v[116:117], v[170:171] op_sel_hi:[1,0,1]
  v_pk_fma_f32 v[32:33], v[32:33], v[118:119], v[172:173] op_sel_hi:[1,0,1]
  v_pk_fma_f32 v[34:35], v[34:35], v[118:119], v[174:175] op_sel_hi:[1,0,1]
  v_pk_fma_f32 v[52:53], v[52:53], v[116:117], v[176:177] op_sel_hi:[1,0,1]
  v_pk_fma_f32 v[54:55], v[54:55], v[116:117], v[178:179] op_sel_hi:[1,0,1]
  v_pk_fma_f32 v[56:57], v[56:57], v[118:119], v[180:181] op_sel_hi:[1,0,1]
  v_pk_fma_f32 v[58:59], v[58:59], v[118:119], v[182:183] op_sel_hi:[1,0,1]
  v_cvt_pk_bf16_f32 v160, v68, v69
  v_cvt_pk_bf16_f32 v161, v70, v71
  buffer_store_dwordx2 v[160:161], v196, s[36:39], s69 offen sc1
  v_cvt_pk_bf16_f32 v164, v72, v73
  v_cvt_pk_bf16_f32 v165, v74, v75
  buffer_store_dwordx2 v[164:165], v197, s[36:39], s69 offen sc1
  v_cvt_pk_bf16_f32 v168, v28, v29
  v_cvt_pk_bf16_f32 v169, v30, v31
  buffer_store_dwordx2 v[168:169], v194, s[36:39], s64 offen sc1
  v_cvt_pk_bf16_f32 v172, v32, v33
  v_cvt_pk_bf16_f32 v173, v34, v35
  buffer_store_dwordx2 v[172:173], v195, s[36:39], s64 offen sc1
  v_cvt_pk_bf16_f32 v176, v52, v53
  v_cvt_pk_bf16_f32 v177, v54, v55
  buffer_store_dwordx2 v[176:177], v194, s[36:39], s67 offen sc1
  v_cvt_pk_bf16_f32 v180, v56, v57
  v_cvt_pk_bf16_f32 v181, v58, v59
  buffer_store_dwordx2 v[180:181], v195, s[36:39], s67 offen sc1
  s_branch Ljoin_3
Lprod_2:
  s_sub_u32 s53, s48, 4
  s_mov_b32 s28, s8
  s_mov_b32 s29, s9
  s_mov_b32 s30, 2097152
  s_mov_b32 s31, 0x20000
  s_mov_b32 s32, s10
  s_mov_b32 s33, s11
  s_mov_b32 s34, 1572864
  s_mov_b32 s35, 0x20000
  v_lshrrev_b32 v2, 3, v1
  v_and_b32 v3, 7, v1
  v_xor_b32 v4, v2, v3
  v_lshlrev_b32 v4, 4, v4
  s_lshl_b32 s54, s53, 4
  v_add_u32 v5, s54, v2
  v_lshl_add_u32 v10, v5, 10, v4
  v_add_u32 v11, 8192, v10
  s_mov_b32 s55, 3072
  v_mul_lo_u32 v5, v5, s55
  v_bfe_u32 v4, v2, 1, 1
  v_lshlrev_b32 v4, 1, v4
  v_xor_b32 v4, v4, v3
  v_lshl_add_u32 v12, v4, 4, v5
  v_xor_b32 v13, 64, v12
  v_add_u32 v13, 24576, v13
  s_lshl_b32 s61, s49, 16
  s_lshl_b32 s62, s50, 7
  s_lshl_b32 s59, s53, 11
  s_add_u32 m0, s59, 0
  s_nop 0
  buffer_load_dwordx4 v10, s[28:31], s61 offen lds
  s_add_u32 m0, s59, 1024
  s_nop 0
  buffer_load_dwordx4 v11, s[28:31], s61 offen lds
  s_add_u32 m0, s59, 8192
  s_nop 0
  buffer_load_dwordx4 v12, s[32:35], s62 offen lds
  s_add_u32 m0, s59, 9216
  s_nop 0
  buffer_load_dwordx4 v13, s[32:35], s62 offen lds
  s_add_u32 m0, s59, 15360
  s_nop 0
  buffer_load_dwordx4 v12, s[32:35], s62 offen offset:1024 lds
  s_add_u32 m0, s59, 16384
  s_nop 0
  buffer_load_dwordx4 v13, s[32:35], s62 offen offset:1024 lds
  s_add_u32 m0, s59, 22528
  s_nop 0
  buffer_load_dwordx4 v12, s[32:35], s62 offen offset:2048 lds
  s_add_u32 m0, s59, 23552
  s_nop 0
  buffer_load_dwordx4 v13, s[32:35], s62 offen offset:2048 lds
  s_add_u32 s61, s61, 128
  s_add_u32 s62, s62, 196608
  s_add_u32 m0, s59, 32768
  s_nop 0
  buffer_load_dwordx4 v10, s[28:31], s61 offen lds
  s_add_u32 m0, s59, 33792
  s_nop 0
  buffer_load_dwordx4 v11, s[28:31], s61 offen lds
  s_add_u32 m0, s59, 40960
  s_nop 0
  buffer_load_dwordx4 v12, s[32:35], s62 offen lds
  s_add_u32 m0, s59, 41984
  s_nop 0
  buffer_load_dwordx4 v13, s[32:35], s62 offen lds
  s_add_u32 m0, s59, 48128
  s_nop 0
  buffer_load_dwordx4 v12, s[32:35], s62 offen offset:1024 lds
  s_add_u32 m0, s59, 49152
  s_nop 0
  buffer_load_dwordx4 v13, s[32:35], s62 offen offset:1024 lds
  s_add_u32 m0, s59, 55296
  s_nop 0
  buffer_load_dwordx4 v12, s[32:35], s62 offen offset:2048 lds
  s_add_u32 m0, s59, 56320
  s_nop 0
  buffer_load_dwordx4 v13, s[32:35], s62 offen offset:2048 lds
  s_add_u32 s61, s61, 128
  s_add_u32 s62, s62, 196608
  s_waitcnt vmcnt(8)
  s_barrier
  s_add_u32 m0, s59, 65536
  s_nop 0
  buffer_load_dwordx4 v10, s[28:31], s61 offen lds
  s_add_u32 m0, s59, 66560
  s_nop 0
  buffer_load_dwordx4 v11, s[28:31], s61 offen lds
  s_add_u32 m0, s59, 73728
  s_nop 0
  buffer_load_dwordx4 v12, s[32:35], s62 offen lds
  s_add_u32 m0, s59, 74752
  s_nop 0
  buffer_load_dwordx4 v13, s[32:35], s62 offen lds
  s_add_u32 m0, s59, 80896
  s_nop 0
  buffer_load_dwordx4 v12, s[32:35], s62 offen offset:1024 lds
  s_add_u32 m0, s59, 81920
  s_nop 0
  buffer_load_dwordx4 v13, s[32:35], s62 offen offset:1024 lds
  s_add_u32 m0, s59, 88064
  s_nop 0
  buffer_load_dwordx4 v12, s[32:35], s62 offen offset:2048 lds
  s_add_u32 m0, s59, 89088
  s_nop 0
  buffer_load_dwordx4 v13, s[32:35], s62 offen offset:2048 lds
  s_add_u32 s61, s61, 128
  s_add_u32 s62, s62, 196608
  s_add_u32 m0, s59, 98304
  s_nop 0
  buffer_load_dwordx4 v10, s[28:31], s61 offen lds
  s_add_u32 m0, s59, 99328
  s_nop 0
  buffer_load_dwordx4 v11, s[28:31], s61 offen lds
  s_add_u32 m0, s59, 106496
  s_nop 0
  buffer_load_dwordx4 v12, s[32:35], s62 offen lds
  s_add_u32 m0, s59, 107520
  s_nop 0
  buffer_load_dwordx4 v13, s[32:35], s62 offen lds
  s_add_u32 m0, s59, 113664
  s_nop 0
  buffer_load_dwordx4 v12, s[32:35], s62 offen offset:1024 lds
  s_add_u32 m0, s59, 114688
  s_nop 0
  buffer_load_dwordx4 v13, s[32:35], s62 offen offset:1024 lds
  s_add_u32 m0, s59, 120832
  s_nop 0
  buffer_load_dwordx4 v12, s[32:35], s62 offen offset:2048 lds
  s_add_u32 m0, s59, 121856
  s_nop 0
  buffer_load_dwordx4 v13, s[32:35], s62 offen offset:2048 lds
  s_add_u32 s61, s61, 128
  s_add_u32 s62, s62, 196608
  v_lshlrev_b32 v60, 4, v1
  s_waitcnt vmcnt(16)
  s_barrier
  s_add_u32 m0, s59, 0
  s_nop 0
  buffer_load_dwordx4 v10, s[28:31], s61 offen lds
  s_add_u32 m0, s59, 1024
  s_nop 0
  buffer_load_dwordx4 v11, s[28:31], s61 offen lds
  s_add_u32 m0, s59, 8192
  s_nop 0
  buffer_load_dwordx4 v12, s[32:35], s62 offen lds
  s_add_u32 m0, s59, 9216
  s_nop 0
  buffer_load_dwordx4 v13, s[32:35], s62 offen lds
  s_add_u32 m0, s59, 15360
  s_nop 0
  buffer_load_dwordx4 v12, s[32:35], s62 offen offset:1024 lds
  s_add_u32 m0, s59, 16384
  s_nop 0
  buffer_load_dwordx4 v13, s[32:35], s62 offen offset:1024 lds
  s_add_u32 m0, s59, 22528
  s_nop 0
  buffer_load_dwordx4 v12, s[32:35], s62 offen offset:2048 lds
  s_add_u32 m0, s59, 23552
  s_nop 0
  buffer_load_dwordx4 v13, s[32:35], s62 offen offset:2048 lds
  s_add_u32 s61, s61, 128
  s_add_u32 s62, s62, 196608
  s_waitcnt vmcnt(16)
  s_barrier
  s_add_u32 m0, s59, 32768
  s_nop 0
  buffer_load_dwordx4 v10, s[28:31], s61 offen lds
  s_add_u32 m0, s59, 33792
  s_nop 0
  buffer_load_dwordx4 v11, s[28:31], s61 offen lds
  s_add_u32 m0, s59, 40960
  s_nop 0
  buffer_load_dwordx4 v12, s[32:35], s62 offen lds
  s_add_u32 m0, s59, 41984
  s_nop 0
  buffer_load_dwordx4 v13, s[32:35], s62 offen lds
  s_add_u32 m0, s59, 48128
  s_nop 0
  buffer_load_dwordx4 v12, s[32:35], s62 offen offset:1024 lds
  s_add_u32 m0, s59, 49152
  s_nop 0
  buffer_load_dwordx4 v13, s[32:35], s62 offen offset:1024 lds
  s_add_u32 m0, s59, 55296
  s_nop 0
  buffer_load_dwordx4 v12, s[32:35], s62 offen offset:2048 lds
  s_add_u32 m0, s59, 56320
  s_nop 0
  buffer_load_dwordx4 v13, s[32:35], s62 offen offset:2048 lds
  s_add_u32 s61, s61, 128
  s_add_u32 s62, s62, 196608
  s_waitcnt vmcnt(16)
  s_barrier
  s_add_u32 m0, s59, 65536
  s_nop 0
  buffer_load_dwordx4 v10, s[28:31], s61 offen lds
  s_add_u32 m0, s59, 66560
  s_nop 0
  buffer_load_dwordx4 v11, s[28:31], s61 offen lds
  s_add_u32 m0, s59, 73728
  s_nop 0
  buffer_load_dwordx4 v12, s[32:35], s62 offen lds
  s_add_u32 m0, s59, 74752
  s_nop 0
  buffer_load_dwordx4 v13, s[32:35], s62 offen lds
  s_add_u32 m0, s59, 80896
  s_nop 0
  buffer_load_dwordx4 v12, s[32:35], s62 offen offset:1024 lds
  s_add_u32 m0, s59, 81920
  s_nop 0
  buffer_load_dwordx4 v13, s[32:35], s62 offen offset:1024 lds
  s_add_u32 m0, s59, 88064
  s_nop 0
  buffer_load_dwordx4 v12, s[32:35], s62 offen offset:2048 lds
  s_add_u32 m0, s59, 89088
  s_nop 0
  buffer_load_dwordx4 v13, s[32:35], s62 offen offset:2048 lds
  s_add_u32 s61, s61, 128
  s_add_u32 s62, s62, 196608
  s_waitcnt vmcnt(16)
  s_barrier
  s_add_u32 m0, s59, 98304
  s_nop 0
  buffer_load_dwordx4 v10, s[28:31], s61 offen lds
  s_add_u32 m0, s59, 99328
  s_nop 0
  buffer_load_dwordx4 v11, s[28:31], s61 offen lds
  s_add_u32 m0, s59, 106496
  s_nop 0
  buffer_load_dwordx4 v12, s[32:35], s62 offen lds
  s_add_u32 m0, s59, 107520
  s_nop 0
  buffer_load_dwordx4 v13, s[32:35], s62 offen lds
  s_add_u32 m0, s59, 113664
  s_nop 0
  buffer_load_dwordx4 v12, s[32:35], s62 offen offset:1024 lds
  s_add_u32 m0, s59, 114688
  s_nop 0
  buffer_load_dwordx4 v13, s[32:35], s62 offen offset:1024 lds
  s_add_u32 m0, s59, 120832
  s_nop 0
  buffer_load_dwordx4 v12, s[32:35], s62 offen offset:2048 lds
  s_add_u32 m0, s59, 121856
  s_nop 0
  buffer_load_dwordx4 v13, s[32:35], s62 offen offset:2048 lds
  s_add_u32 s61, s61, 128
  s_add_u32 s62, s62, 196608
  v_mov_b32 v48, 0
  global_load_dword v49, v48, s[24:25] sc1
  s_waitcnt vmcnt(17)
  s_barrier
  s_lshr_b32 s54, s2, 4
  s_bfe_u32 s55, s2, 0x30001
  s_mul_i32 s54, s54, 224
  s_mul_i32 s55, s55, 229376
  s_add_u32 s54, s54, s55
  s_mul_i32 s55, s53, 57344
  s_add_u32 s54, s54, s55
  v_lshrrev_b32 v2, 4, v1
  v_and_b32 v3, 15, v1
  v_min_u32 v3, 13, v3
  v_mul_u32_u24 v4, 3584, v2
  v_lshl_add_u32 v4, v3, 4, v4
  s_bitcmp1_b32 s2, 0
  s_cselect_b32 s40, s18, s16
  s_cselect_b32 s41, s19, s17
  s_mov_b32 s42, 1835008
  s_mov_b32 s43, 0x20000
  buffer_load_dwordx4 v[16:19], v4, s[40:43], s54 offen
  s_add_u32 s54, s54, 14336
  buffer_load_dwordx4 v[20:23], v4, s[40:43], s54 offen
  s_add_u32 s54, s54, 14336
  buffer_load_dwordx4 v[24:27], v4, s[40:43], s54 offen
  s_add_u32 s54, s54, 14336
  buffer_load_dwordx4 v[28:31], v4, s[40:43], s54 offen
  s_add_u32 s54, s54, 14336
  s_waitcnt vmcnt(13)
  s_barrier
  s_waitcnt vmcnt(5)
  s_barrier
  s_waitcnt vmcnt(0)
  s_waitcnt vmcnt(4)
  v_readfirstlane_b32 s4, v49
  s_cmp_lg_u32 s4, 0
  s_cbranch_scc1 Lnn_25
  s_mov_b32 s3, 0
  v_mov_b32 v3, 0
Lp_26:
  global_load_dword v2, v3, s[24:25] sc1
  s_waitcnt vmcnt(0)
  v_readfirstlane_b32 s4, v2
  s_cmp_lg_u32 s4, 0
  s_cbranch_scc1 Lo_27
  s_add_u32 s3, s3, 1
  s_cmp_lt_u32 s3, 400000
  s_cbranch_scc1 Lp_26
Lo_27:
Lnn_25:
  s_add_u32 s36, s26, 19922944
  s_addc_u32 s37, s27, 0
  s_mov_b32 s38, 4194304
  s_mov_b32 s39, 0x20000
  v_lshrrev_b32 v2, 4, v1
  v_bfe_u32 v3, v1, 1, 3
  v_xor_b32 v3, v3, v2
  v_and_b32 v4, 1, v1
  v_lshlrev_b32 v4, 4, v4
  v_lshl_add_u32 v5, v3, 5, v4
  v_lshl_add_u32 v5, v2, 8, v5
  v_xor_b32 v6, 128, v5
  v_and_b32 v7, 15, v1
  v_mov_b32 v8, 0x7fffffff
  v_cmp_gt_u32 vcc, 14, v7
  s_nop 1
  v_cndmask_b32 v5, v8, v5, vcc
  v_cndmask_b32 v6, v8, v6, vcc
  s_lshl_b32 s54, s2, 14
  s_lshl_b32 s55, s53, 12
  s_add_u32 s54, s54, s55
  buffer_store_dwordx4 v[16:19], v5, s[36:39], s54 offen offset:0 sc1
  buffer_store_dwordx4 v[20:23], v5, s[36:39], s54 offen offset:1024 sc1
  buffer_store_dwordx4 v[24:27], v6, s[36:39], s54 offen offset:2048 sc1
  buffer_store_dwordx4 v[28:31], v6, s[36:39], s54 offen offset:3072 sc1
  v_and_b32 v2, 7, v1
  v_lshrrev_b32 v4, 1, v2
  v_and_b32 v2, 1, v2
  v_lshlrev_b32 v2, 4, v2
  v_mov_b32 v3, 0x3f80
  v_lshlrev_b32 v2, v2, v3
  v_cmp_eq_u32 vcc, 0, v4
  s_nop 1
  v_cndmask_b32 v32, 0, v2, vcc
  v_cmp_eq_u32 vcc, 1, v4
  s_nop 1
  v_cndmask_b32 v33, 0, v2, vcc
  v_cmp_eq_u32 vcc, 2, v4
  s_nop 1
  v_cndmask_b32 v34, 0, v2, vcc
  v_cmp_eq_u32 vcc, 3, v4
  s_nop 1
  v_cndmask_b32 v35, 0, v2, vcc
  s_nop 1
  v_mfma_f32_16x16x32_bf16 v[36:39], v[32:35], v[16:19], 0
  v_mfma_f32_16x16x32_bf16 v[36:39], v[32:35], v[20:23], v[36:39]
  v_mfma_f32_16x16x32_bf16 v[36:39], v[32:35], v[24:27], v[36:39]
  v_mfma_f32_16x16x32_bf16 v[36:39], v[32:35], v[28:31], v[36:39]
  s_lshl_b32 s54, s53, 9
  s_add_u32 s54, s54, 131072
  v_lshl_add_u32 v4, v7, 5, s54
  v_bfe_u32 v2, v1, 4, 1
  v_lshl_add_u32 v4, v2, 4, v4
  s_nop 2
  ds_write_b128 v4, v[36:39]
  s_waitcnt lgkmcnt(0)
  s_barrier
  v_subrev_u32 v9, 256, v0
  v_lshlrev_b32 v4, 2, v9
  v_add_u32 v3, 131072, v4
  ds_read_b32 v32, v3 offset:0
  ds_read_b32 v33, v3 offset:512
  ds_read_b32 v34, v3 offset:1024
  ds_read_b32 v35, v3 offset:1536
  s_waitcnt lgkmcnt(0)
  v_add_f32 v32, v32, v33
  v_add_f32 v34, v34, v35
  v_add_f32 v32, v32, v34
  s_add_u32 s36, s26, 10747904
  s_addc_u32 s37, s27, 0
  s_mov_b32 s38, 114688
  s_mov_b32 s39, 0x20000
  s_and_b32 s54, s2, 15
  s_mul_i32 s54, s54, 7168
  s_lshr_b32 s55, s2, 4
  s_mul_i32 s55, s55, 448
  s_add_u32 s54, s54, s55
  v_mov_b32 v3, 0x7fffffff
  v_cmp_gt_u32 vcc, 112, v9
  s_nop 1
  v_cndmask_b32 v4, v3, v4, vcc
  buffer_store_dword v32, v4, s[36:39], s54 offen sc1
Ljoin_3:
  s_lshl_b32 s58, s49, 3
  s_add_u32 s58, s58, s50
  s_mov_b32 s14, s58
  s_mov_b32 s15, s2
  s_mov_b32 s49, s72
  s_mov_b32 s50, s73
  s_and_b32 s53, s48, 1
  s_lshr_b32 s52, s48, 1
  v_min_u32 v5, 5, v1
  s_lshl_b32 s54, s5, 1
  s_sub_i32 s54, s54, 4
  v_add_u32 v5, s54, v5
  v_max_i32 v5, 0, v5
  v_lshlrev_b32 v5, 3, v5
  s_lshr_b32 s54, s6, 1
  v_add_u32 v5, s54, v5
  v_lshlrev_b32 v5, 7, v5
  v_add_u32 v138, 32768, v5
  v_bfe_u32 v2, v1, 4, 1
  v_and_b32 v3, 1, v1
  v_xor_b32 v2, v2, v3
  v_lshrrev_b32 v3, 1, v1
  v_lshlrev_b32 v3, 5, v3
  v_lshl_add_u32 v142, v2, 4, v3
  v_lshlrev_b32 v145, 4, v1
  s_lshl_b32 s54, s6, 1
  s_add_u32 s54, s54, s53
  s_lshl_b32 s54, s54, 16
  s_lshl_b32 s55, s5, 2
  s_mul_i32 s56, s52, 3
  s_add_u32 s55, s55, s56
  s_sub_i32 s56, s55, 8
  s_max_i32 s56, s56, 0
  s_lshl_b32 s56, s56, 10
  s_add_u32 s64, s56, s54
  s_sub_i32 s56, s55, 7
  s_max_i32 s56, s56, 0
  s_lshl_b32 s56, s56, 10
  s_add_u32 s65, s56, s54
  s_sub_i32 s56, s55, 6
  s_max_i32 s56, s56, 0
  s_lshl_b32 s56, s56, 10
  s_add_u32 s66, s56, s54
  s_mul_i32 s69, s53, 24576
  s_mul_i32 s56, s52, 3072
  s_add_u32 s70, s69, s56
  s_lshl_b32 s58, s5, 2
  s_add_u32 s58, s58, s52
  s_lshl_b32 s56, s58, 10
  s_add_u32 s71, s56, s54
  s_sub_i32 s59, 8, s58
  s_max_i32 s59, s59, 0
  s_mov_b32 s28, s26
  s_mov_b32 s29, s27
  s_mov_b32 s30, 2097152
  s_mov_b32 s31, 0x20000
  s_add_u32 s32, s26, 2097152
  s_addc_u32 s33, s27, 0
  s_mov_b32 s34, 2097152
  s_mov_b32 s35, 0x20000
  s_add_u32 s36, s26, 4194304
  s_addc_u32 s37, s27, 0
  s_mov_b32 s38, 2097152
  s_mov_b32 s39, 0x20000
  v_and_b32 v2, 31, v1
  v_lshrrev_b32 v3, 5, v1
  v_lshlrev_b32 v7, 5, v2
  v_lshl_add_u32 v146, v3, 4, v7
  s_add_u32 s40, s26, 6291456
  s_addc_u32 s41, s27, 0
  s_mov_b32 s42, 2097152
  s_mov_b32 s43, 0x20000
  v_and_b32 v2, 31, v1
  v_lshrrev_b32 v3, 5, v1
  v_lshlrev_b32 v152, 5, v2
  v_bfe_u32 v9, v1, 3, 1
  v_xor_b32 v9, v9, v3
  v_lshl_add_u32 v140, v9, 4, v152
  v_add_u32 v153, s70, v140
  s_lshl_b32 s56, s52, 10
  s_add_u32 s56, s56, s69
  v_add_u32 v140, s56, v140
  s_add_u32 s56, s56, 12288
  v_add_u32 v141, s56, v146
  v_add_u32 v139, 56832, v146
  v_mov_b32 v144, 1024
  v_mov_b32 v136, 0
  v_cmp_gt_u32 vcc, 16, v2
  s_nop 1
  v_cndmask_b32 v141, v139, v141, vcc
  v_cndmask_b32 v144, v136, v144, vcc
  v_bfe_u32 v139, v1, 1, 4
  v_and_b32 v139, 11, v139
  v_cmp_eq_u32 vcc, 0, v139
  v_mov_b32 v139, s60
  s_nop 0
  v_cndmask_b32 v16, v136, v139, vcc
  v_mov_b32 v17, v16
  v_mov_b32 v18, v16
  v_mov_b32 v19, v16
  v_lshlrev_b32 v139, 4, v1
  v_add_u32 v139, 57344, v139
  ds_write_b128 v139, v[16:19]
  v_lshlrev_b32 v3, 2, v3
  v_sub_u32 v2, v2, v3
  v_cvt_f32_i32 v151, v2
  v_add_f32 v151, 0.5, v151
  v_mov_b32 v136, 0xf149f2ca
  v_fmaak_f32 v120, v151, v136, 0x00000000
  v_fmaak_f32 v121, v151, v136, 0x7149f2ca
  v_fmaak_f32 v122, v151, v136, 0x71c9f2ca
  v_fmaak_f32 v123, v151, v136, 0x72177617
  v_fmaak_f32 v124, v151, v136, 0x72c9f2ca
  v_fmaak_f32 v125, v151, v136, 0x72e33123
  v_fmaak_f32 v126, v151, v136, 0x72fc6f7c
  v_fmaak_f32 v127, v151, v136, 0x730ad6eb
  v_fmaak_f32 v128, v151, v136, 0x7349f2ca
  v_fmaak_f32 v129, v151, v136, 0x735691f6
  v_fmaak_f32 v130, v151, v136, 0x73633123
  v_fmaak_f32 v131, v151, v136, 0x736fd050
  v_fmaak_f32 v132, v151, v136, 0x73977617
  v_fmaak_f32 v133, v151, v136, 0x739dc5ae
  v_fmaak_f32 v134, v151, v136, 0x73a41544
  v_fmaak_f32 v135, v151, v136, 0x73aa64da
  v_min_f32 v88, 0, v120
  v_min_f32_e64 v104, 0, -v120
  v_min_f32 v89, 0, v121
  v_min_f32_e64 v105, 0, -v121
  v_min_f32 v90, 0, v122
  v_min_f32_e64 v106, 0, -v122
  v_min_f32 v91, 0, v123
  v_min_f32_e64 v107, 0, -v123
  v_min_f32 v92, 0, v124
  v_min_f32_e64 v108, 0, -v124
  v_min_f32 v93, 0, v125
  v_min_f32_e64 v109, 0, -v125
  v_min_f32 v94, 0, v126
  v_min_f32_e64 v110, 0, -v126
  v_min_f32 v95, 0, v127
  v_min_f32_e64 v111, 0, -v127
  v_min_f32 v96, 0, v128
  v_min_f32_e64 v112, 0, -v128
  v_min_f32 v97, 0, v129
  v_min_f32_e64 v113, 0, -v129
  v_min_f32 v98, 0, v130
  v_min_f32_e64 v114, 0, -v130
  v_min_f32 v99, 0, v131
  v_min_f32_e64 v115, 0, -v131
  v_min_f32 v100, 0, v132
  v_min_f32_e64 v116, 0, -v132
  v_min_f32 v101, 0, v133
  v_min_f32_e64 v117, 0, -v133
  v_min_f32 v102, 0, v134
  v_min_f32_e64 v118, 0, -v134
  v_min_f32 v103, 0, v135
  v_min_f32_e64 v119, 0, -v135
  v_mov_b64 v[72:73], 0
  v_mov_b64 v[74:75], 0
  v_mov_b64 v[76:77], 0
  v_mov_b64 v[78:79], 0
  v_mov_b64 v[80:81], 0
  v_mov_b64 v[82:83], 0
  v_mov_b64 v[84:85], 0
  v_mov_b64 v[86:87], 0
  v_lshrrev_b32 v2, 3, v1
  v_and_b32 v3, 7, v1
  v_bfe_u32 v149, v2, 1, 1
  s_and_b32 s54, s48, 1
  s_lshl_b32 s54, s54, 1
  v_or_b32 v149, s54, v149
  v_lshlrev_b32 v149, 1, v149
  v_xor_b32 v3, v3, v149
  v_lshlrev_b32 v3, 4, v3
  s_lshl_b32 s54, s48, 3
  v_add_u32 v2, s54, v2
  s_mov_b32 s54, 1024
  v_mul_lo_u32 v2, v2, s54
  v_add_u32 v148, v2, v3
  s_lshl_b32 s62, s50, 7
  s_waitcnt vmcnt(0)
  s_barrier
  s_cmp_eq_u32 s48, 0
  s_cbranch_scc0 Lsig_28
  s_lshl_b32 s54, s14, 7
  s_add_u32 s54, s54, 32768
  v_mov_b32 v2, s4
  v_mov_b32 v3, 0
  s_mov_b64 exec, 1
  buffer_store_dword v2, v3, s[44:47], s54 offen sc1
  s_mov_b64 exec, -1
  s_lshl_b32 s54, s15, 7
  s_add_u32 s54, s54, 0
  v_mov_b32 v2, s4
  v_mov_b32 v3, 0
  s_mov_b64 exec, 1
  buffer_store_dword v2, v3, s[44:47], s54 offen sc1
  s_mov_b64 exec, -1
Lsig_28:
  s_cmp_eq_u32 s48, 0
  s_cbranch_scc0 Lw_29
  s_mov_b32 s3, 0
Lp_30:
  buffer_load_dword v2, v138, s[44:47], 0 offen sc1
  s_waitcnt vmcnt(0)
  v_cmp_ne_u32 vcc, s4, v2
  s_cbranch_vccz Lo_31
  s_add_u32 s3, s3, 1
  s_cmp_lt_u32 s3, 400000
  s_cbranch_scc1 Lp_30
Lo_31:
Lw_29:
  s_barrier
  buffer_load_dwordx4 v[4:7], v146, s[28:31], s71 offen sc1
  s_add_u32 m0, s70, 0
  s_nop 0
  buffer_load_dwordx4 v142, s[32:35], s64 offen sc1 lds
  s_add_u32 m0, s70, 1024
  s_nop 0
  buffer_load_dwordx4 v142, s[32:35], s65 offen sc1 lds
  s_add_u32 m0, s70, 2048
  s_nop 0
  buffer_load_dwordx4 v142, s[32:35], s66 offen sc1 lds
  v_and_b32 v147, 15, v1
  s_lshl_b32 s54, s1, 4
  v_add_u32 v147, s54, v147
  v_lshlrev_b32 v147, 7, v147
  s_barrier
  s_add_u32 m0, s70, 12288
  s_nop 0
  buffer_load_dwordx4 v145, s[36:39], s64 offen sc1 lds
  s_add_u32 m0, s70, 13312
  s_nop 0
  buffer_load_dwordx4 v145, s[36:39], s65 offen sc1 lds
  s_add_u32 m0, s70, 14336
  s_nop 0
  buffer_load_dwordx4 v145, s[36:39], s66 offen sc1 lds
  buffer_load_dword v150, v147, s[44:47], 0 offen sc1
  s_waitcnt vmcnt(4)
  ds_read_b128 v[32:35], v153 offset:0
  ds_read_b128 v[36:39], v153 offset:1024
  ds_read_b128 v[40:43], v153 offset:2048
  v_mov_b32 v48, 0
  v_dot2_f32_bf16 v48, v4, v4, v48
  v_dot2_f32_bf16 v48, v5, v5, v48
  v_dot2_f32_bf16 v48, v6, v6, v48
  v_dot2_f32_bf16 v48, v7, v7, v48
  v_mov_b32 v49, 0
  v_mov_b32 v50, 0
  v_mov_b32 v51, 0
  s_waitcnt lgkmcnt(0)
  v_dot2_f32_bf16 v49, v32, v32, v49
  v_dot2_f32_bf16 v50, v36, v36, v50
  v_dot2_f32_bf16 v51, v40, v40, v51
  v_dot2_f32_bf16 v49, v33, v33, v49
  v_dot2_f32_bf16 v50, v37, v37, v50
  v_dot2_f32_bf16 v51, v41, v41, v51
  v_dot2_f32_bf16 v49, v34, v34, v49
  v_dot2_f32_bf16 v50, v38, v38, v50
  v_dot2_f32_bf16 v51, v42, v42, v51
  v_dot2_f32_bf16 v49, v35, v35, v49
  v_dot2_f32_bf16 v50, v39, v39, v50
  v_dot2_f32_bf16 v51, v43, v43, v51
  v_mov_b32 v52, v48
  v_mov_b32 v53, v49
  v_mov_b32 v54, v50
  v_mov_b32 v55, v51
  v_permlane32_swap_b32 v48, v52
  v_permlane32_swap_b32 v49, v53
  v_permlane32_swap_b32 v50, v54
  v_permlane32_swap_b32 v51, v55
  v_add_f32 v48, v48, v52
  v_add_f32 v49, v49, v53
  v_add_f32 v50, v50, v54
  v_add_f32 v51, v51, v55
  v_max3_f32 v49, v49, v50, v51
  s_nop 1
  v_max_f32_dpp v49, v49, v49 row_ror:8 row_mask:0xf bank_mask:0xf
  s_nop 1
  v_max_f32_dpp v49, v49, v49 row_ror:4 row_mask:0xf bank_mask:0xf
  s_nop 1
  v_max_f32_dpp v49, v49, v49 row_ror:2 row_mask:0xf bank_mask:0xf
  s_nop 1
  v_max_f32_dpp v49, v49, v49 row_ror:1 row_mask:0xf bank_mask:0xf
  v_mov_b32 v50, v49
  s_nop 1
  v_permlane16_swap_b32 v49, v50
  v_max_f32 v49, v49, v50
  s_lshl_b32 s54, s53, 4
  s_lshl_b32 s55, s52, 2
  s_add_u32 s54, s54, s55
  s_add_u32 s54, s54, 58368
  v_mov_b32 v50, s54
  ds_write_b32 v50, v49
  s_waitcnt lgkmcnt(0)
  s_barrier
  s_lshl_b32 s54, s53, 4
  s_add_u32 s54, s54, 58368
  v_mov_b32 v50, s54
  ds_read_b128 v[32:35], v50
  s_mov_b32 s28, s12
  s_mov_b32 s29, s13
  s_mov_b32 s30, 524288
  s_mov_b32 s31, 0x20000
  s_add_u32 s36, s26, 19922944
  s_addc_u32 s37, s27, 0
  s_mov_b32 s38, 4194304
  s_mov_b32 s39, 0x20000
  s_lshl_b32 s64, s1, 18
  s_and_b32 s54, s0, 7
  s_lshl_b32 s54, s54, 15
  s_add_u32 s64, s64, s54
  s_lshl_b32 s54, s48, 12
  s_add_u32 s64, s64, s54
  s_waitcnt lgkmcnt(0)
  v_max3_f32 v32, v32, v33, v34
  v_max_f32 v32, v32, v35
  v_mul_f32 v136, v32, v48
  v_sqrt_f32 v136, v136
  s_nop 0
  v_mul_f32 v136, 0x3f808000, v136
  v_pk_add_f32 v[88:89], v[88:89], v[136:137] op_sel_hi:[1,0] neg_lo:[0,1] neg_hi:[0,1]
  v_pk_add_f32 v[104:105], v[104:105], v[136:137] op_sel_hi:[1,0] neg_lo:[0,1] neg_hi:[0,1]
  v_pk_add_f32 v[90:91], v[90:91], v[136:137] op_sel_hi:[1,0] neg_lo:[0,1] neg_hi:[0,1]
  v_pk_add_f32 v[106:107], v[106:107], v[136:137] op_sel_hi:[1,0] neg_lo:[0,1] neg_hi:[0,1]
  v_pk_add_f32 v[92:93], v[92:93], v[136:137] op_sel_hi:[1,0] neg_lo:[0,1] neg_hi:[0,1]
  v_pk_add_f32 v[108:109], v[108:109], v[136:137] op_sel_hi:[1,0] neg_lo:[0,1] neg_hi:[0,1]
  v_pk_add_f32 v[94:95], v[94:95], v[136:137] op_sel_hi:[1,0] neg_lo:[0,1] neg_hi:[0,1]
  v_pk_add_f32 v[110:111], v[110:111], v[136:137] op_sel_hi:[1,0] neg_lo:[0,1] neg_hi:[0,1]
  v_pk_add_f32 v[96:97], v[96:97], v[136:137] op_sel_hi:[1,0] neg_lo:[0,1] neg_hi:[0,1]
  v_pk_add_f32 v[112:113], v[112:113], v[136:137] op_sel_hi:[1,0] neg_lo:[0,1] neg_hi:[0,1]
  v_pk_add_f32 v[98:99], v[98:99], v[136:137] op_sel_hi:[1,0] neg_lo:[0,1] neg_hi:[0,1]
  v_pk_add_f32 v[114:115], v[114:115], v[136:137] op_sel_hi:[1,0] neg_lo:[0,1] neg_hi:[0,1]
  v_pk_add_f32 v[100:101], v[100:101], v[136:137] op_sel_hi:[1,0] neg_lo:[0,1] neg_hi:[0,1]
  v_pk_add_f32 v[116:117], v[116:117], v[136:137] op_sel_hi:[1,0] neg_lo:[0,1] neg_hi:[0,1]
  v_pk_add_f32 v[102:103], v[102:103], v[136:137] op_sel_hi:[1,0] neg_lo:[0,1] neg_hi:[0,1]
  v_pk_add_f32 v[118:119], v[118:119], v[136:137] op_sel_hi:[1,0] neg_lo:[0,1] neg_hi:[0,1]
  v_sub_f32 v120, 0, v136
  v_mov_b32 v121, v120
  v_mov_b64 v[122:123], v[120:121]
  v_mov_b64 v[124:125], v[120:121]
  v_mov_b64 v[126:127], v[120:121]
  v_mov_b64 v[128:129], v[120:121]
  v_mov_b64 v[130:131], v[120:121]
  v_mov_b64 v[132:133], v[120:121]
  v_mov_b64 v[134:135], v[120:121]
  s_mov_b32 s7, 0
  s_waitcnt vmcnt(0)
  v_cmp_ne_u32 vcc, s4, v150
  s_cbranch_vccz Lok_32
  s_mov_b32 s3, 0
Lp_33:
  buffer_load_dword v2, v147, s[44:47], 0 offen sc1
  s_waitcnt vmcnt(0)
  v_cmp_ne_u32 vcc, s4, v2
  s_cbranch_vccz Lo_34
  s_add_u32 s3, s3, 1
  s_cmp_lt_u32 s3, 400000
  s_cbranch_scc1 Lp_33
Lo_34:
Lok_32:
  s_barrier
Lmain_35:
  s_cmp_eq_u32 s59, 8
  s_cbranch_scc1 A2_38_E8
  s_cmp_eq_u32 s59, 7
  s_cbranch_scc1 A2_38_E7
  s_cmp_eq_u32 s59, 6
  s_cbranch_scc1 A2_38_E6
  s_cmp_eq_u32 s59, 5
  s_cbranch_scc1 A2_38_E5
  s_cmp_eq_u32 s59, 4
  s_cbranch_scc1 A2_38_E4
  s_cmp_eq_u32 s59, 3
  s_cbranch_scc1 A2_38_E3
  s_cmp_eq_u32 s59, 2
  s_cbranch_scc1 A2_38_E2
  s_cmp_eq_u32 s59, 1
  s_cbranch_scc1 A2_38_E1
  ds_read_b128 v[8:11], v140 offset:0
  v_mad_u32_u24 v143, v144, 0, v141
  ds_read_b128 v[16:19], v143
  ds_read_b128 v[20:23], v143 offset:512
  s_waitcnt lgkmcnt(0)
  v_mfma_f32_32x32x16_bf16 v[32:47], v[8:11], v[4:7], v[88:103]
  ds_read_b128 v[12:15], v140 offset:1024
  s_branch A2_38_B0
A2_38_E1:
  s_add_u32 s65, s62, 0
  s_add_u32 m0, s51, 65536
  s_nop 0
  buffer_load_dwordx4 v148, s[28:31], s65 offen lds
  ds_read_b128 v[12:15], v140 offset:1024
  v_mad_u32_u24 v143, v144, 1, v141
  ds_read_b128 v[24:27], v143
  ds_read_b128 v[28:31], v143 offset:512
  s_waitcnt lgkmcnt(0)
  v_mfma_f32_32x32x16_bf16 v[48:63], v[12:15], v[4:7], v[120:135]
  ds_read_b128 v[8:11], v140 offset:2048
  s_branch A2_38_B1
A2_38_E2:
  s_add_u32 s65, s62, 0
  s_add_u32 m0, s51, 65536
  s_nop 0
  buffer_load_dwordx4 v148, s[28:31], s65 offen lds
  s_add_u32 s65, s62, 65536
  s_add_u32 m0, s51, 73728
  s_nop 0
  buffer_load_dwordx4 v148, s[28:31], s65 offen lds
  ds_read_b128 v[8:11], v140 offset:2048
  v_mad_u32_u24 v143, v144, 2, v141
  ds_read_b128 v[16:19], v143
  ds_read_b128 v[20:23], v143 offset:512
  s_waitcnt lgkmcnt(0)
  v_mfma_f32_32x32x16_bf16 v[32:47], v[8:11], v[4:7], v[120:135]
  ds_read_b128 v[12:15], v140 offset:3072
  s_branch A2_38_B2
A2_38_E3:
  s_add_u32 s65, s62, 0
  s_add_u32 m0, s51, 65536
  s_nop 0
  buffer_load_dwordx4 v148, s[28:31], s65 offen lds
  s_add_u32 s65, s62, 65536
  s_add_u32 m0, s51, 73728
  s_nop 0
  buffer_load_dwordx4 v148, s[28:31], s65 offen lds
  s_add_u32 s65, s62, 131072
  s_add_u32 m0, s51, 81920
  s_nop 0
  buffer_load_dwordx4 v148, s[28:31], s65 offen lds
  ds_read_b128 v[12:15], v140 offset:3072
  v_mad_u32_u24 v143, v144, 3, v141
  ds_read_b128 v[24:27], v143
  ds_read_b128 v[28:31], v143 offset:512
  s_waitcnt lgkmcnt(0)
  v_mfma_f32_32x32x16_bf16 v[48:63], v[12:15], v[4:7], v[120:135]
  ds_read_b128 v[8:11], v140 offset:4096
  s_branch A2_38_B3
A2_38_E4:
  s_add_u32 s65, s62, 0
  s_add_u32 m0, s51, 65536
  s_nop 0
  buffer_load_dwordx4 v148, s[28:31], s65 offen lds
  s_add_u32 s65, s62, 65536
  s_add_u32 m0, s51, 73728
  s_nop 0
  buffer_load_dwordx4 v148, s[28:31], s65 offen lds
  s_add_u32 s65, s62, 131072
  s_add_u32 m0, s51, 81920
  s_nop 0
  buffer_load_dwordx4 v148, s[28:31], s65 offen lds
  s_add_u32 s65, s62, 196608
  s_add_u32 m0, s51, 90112
  s_nop 0
  buffer_load_dwordx4 v148, s[28:31], s65 offen lds
  ds_read_b128 v[8:11], v140 offset:4096
  v_mad_u32_u24 v143, v144, 4, v141
  ds_read_b128 v[16:19], v143
  ds_read_b128 v[20:23], v143 offset:512
  s_waitcnt lgkmcnt(0)
  v_mfma_f32_32x32x16_bf16 v[32:47], v[8:11], v[4:7], v[120:135]
  ds_read_b128 v[12:15], v140 offset:5120
  s_branch A2_38_B4
A2_38_E5:
  s_add_u32 s65, s62, 0
  s_add_u32 m0, s51, 65536
  s_nop 0
  buffer_load_dwordx4 v148, s[28:31], s65 offen lds
  s_add_u32 s65, s62, 65536
  s_add_u32 m0, s51, 73728
  s_nop 0
  buffer_load_dwordx4 v148, s[28:31], s65 offen lds
  s_add_u32 s65, s62, 131072
  s_add_u32 m0, s51, 81920
  s_nop 0
  buffer_load_dwordx4 v148, s[28:31], s65 offen lds
  s_add_u32 s65, s62, 196608
  s_add_u32 m0, s51, 90112
  s_nop 0
  buffer_load_dwordx4 v148, s[28:31], s65 offen lds
  s_add_u32 s65, s62, 262144
  s_add_u32 m0, s51, 98304
  s_nop 0
  buffer_load_dwordx4 v148, s[28:31], s65 offen lds
  ds_read_b128 v[12:15], v140 offset:5120
  v_mad_u32_u24 v143, v144, 5, v141
  ds_read_b128 v[24:27], v143
  ds_read_b128 v[28:31], v143 offset:512
  s_waitcnt lgkmcnt(0)
  v_mfma_f32_32x32x16_bf16 v[48:63], v[12:15], v[4:7], v[120:135]
  ds_read_b128 v[8:11], v140 offset:6144
  s_branch A2_38_B5
A2_38_E6:
  s_add_u32 s65, s62, 0
  s_add_u32 m0, s51, 65536
  s_nop 0
  buffer_load_dwordx4 v148, s[28:31], s65 offen lds
  s_add_u32 s65, s62, 65536
  s_add_u32 m0, s51, 73728
  s_nop 0
  buffer_load_dwordx4 v148, s[28:31], s65 offen lds
  s_add_u32 s65, s62, 131072
  s_add_u32 m0, s51, 81920
  s_nop 0
  buffer_load_dwordx4 v148, s[28:31], s65 offen lds
  s_add_u32 s65, s62, 196608
  s_add_u32 m0, s51, 90112
  s_nop 0
  buffer_load_dwordx4 v148, s[28:31], s65 offen lds
  s_add_u32 s65, s62, 262144
  s_add_u32 m0, s51, 98304
  s_nop 0
  buffer_load_dwordx4 v148, s[28:31], s65 offen lds
  s_add_u32 s65, s62, 327680
  s_add_u32 m0, s51, 106496
  s_nop 0
  buffer_load_dwordx4 v148, s[28:31], s65 offen lds
  ds_read_b128 v[8:11], v140 offset:6144
  v_mad_u32_u24 v143, v144, 6, v141
  ds_read_b128 v[16:19], v143
  ds_read_b128 v[20:23], v143 offset:512
  s_waitcnt lgkmcnt(0)
  v_mfma_f32_32x32x16_bf16 v[32:47], v[8:11], v[4:7], v[120:135]
  ds_read_b128 v[12:15], v140 offset:7168
  s_branch A2_38_B6
A2_38_E7:
  s_add_u32 s65, s62, 0
  s_add_u32 m0, s51, 65536
  s_nop 0
  buffer_load_dwordx4 v148, s[28:31], s65 offen lds
  s_add_u32 s65, s62, 65536
  s_add_u32 m0, s51, 73728
  s_nop 0
  buffer_load_dwordx4 v148, s[28:31], s65 offen lds
  s_add_u32 s65, s62, 131072
  s_add_u32 m0, s51, 81920
  s_nop 0
  buffer_load_dwordx4 v148, s[28:31], s65 offen lds
  s_add_u32 s65, s62, 196608
  s_add_u32 m0, s51, 90112
  s_nop 0
  buffer_load_dwordx4 v148, s[28:31], s65 offen lds
  s_add_u32 s65, s62, 262144
  s_add_u32 m0, s51, 98304
  s_nop 0
  buffer_load_dwordx4 v148, s[28:31], s65 offen lds
  s_add_u32 s65, s62, 327680
  s_add_u32 m0, s51, 106496
  s_nop 0
  buffer_load_dwordx4 v148, s[28:31], s65 offen lds
  s_add_u32 s65, s62, 393216
  s_add_u32 m0, s51, 114688
  s_nop 0
  buffer_load_dwordx4 v148, s[28:31], s65 offen lds
  s_add_u32 s65, s62, 458752
  s_add_u32 m0, s51, 122880
  s_nop 0
  buffer_load_dwordx4 v148, s[28:31], s65 offen lds
  ds_read_b128 v[12:15], v140 offset:7168
  v_mad_u32_u24 v143, v144, 7, v141
  ds_read_b128 v[24:27], v143
  ds_read_b128 v[28:31], v143 offset:512
  s_waitcnt lgkmcnt(0)
  v_mfma_f32_32x32x16_bf16 v[48:63], v[12:15], v[4:7], v[120:135]
  ds_read_b128 v[8:11], v140 offset:8192
  s_branch A2_38_B7
A2_38_E8:
  s_add_u32 s65, s62, 0
  s_add_u32 m0, s51, 65536
  s_nop 0
  buffer_load_dwordx4 v148, s[28:31], s65 offen lds
  s_add_u32 s65, s62, 65536
  s_add_u32 m0, s51, 73728
  s_nop 0
  buffer_load_dwordx4 v148, s[28:31], s65 offen lds
  s_add_u32 s65, s62, 131072
  s_add_u32 m0, s51, 81920
  s_nop 0
  buffer_load_dwordx4 v148, s[28:31], s65 offen lds
  s_add_u32 s65, s62, 196608
  s_add_u32 m0, s51, 90112
  s_nop 0
  buffer_load_dwordx4 v148, s[28:31], s65 offen lds
  s_add_u32 s65, s62, 262144
  s_add_u32 m0, s51, 98304
  s_nop 0
  buffer_load_dwordx4 v148, s[28:31], s65 offen lds
  s_add_u32 s65, s62, 327680
  s_add_u32 m0, s51, 106496
  s_nop 0
  buffer_load_dwordx4 v148, s[28:31], s65 offen lds
  s_add_u32 s65, s62, 393216
  s_add_u32 m0, s51, 114688
  s_nop 0
  buffer_load_dwordx4 v148, s[28:31], s65 offen lds
  s_add_u32 s65, s62, 458752
  s_add_u32 m0, s51, 122880
  s_nop 0
  buffer_load_dwordx4 v148, s[28:31], s65 offen lds
  ds_read_b128 v[8:11], v140 offset:8192
  v_mad_u32_u24 v143, v144, 8, v141
  ds_read_b128 v[16:19], v143
  ds_read_b128 v[20:23], v143 offset:512
  s_waitcnt lgkmcnt(0)
  v_mfma_f32_32x32x16_bf16 v[32:47], v[8:11], v[4:7], v[104:119]
  s_branch A2_38_B8
A2_38_B0:
  s_waitcnt lgkmcnt(0)
  s_add_u32 s65, s62, 0
  s_add_u32 m0, s51, 65536
  s_nop 0
  buffer_load_dwordx4 v148, s[28:31], s65 offen lds
  s_add_u32 s65, s64, 0
  buffer_load_dwordx4 v[240:243], v145, s[36:39], s65 offen sc1
  v_mfma_f32_32x32x16_bf16 v[48:63], v[12:15], v[4:7], v[120:135]
  ds_read_b128 v[8:11], v140 offset:2048
  v_add_u32 v143, v143, v144
  ds_read_b128 v[24:27], v143
  ds_read_b128 v[28:31], v143 offset:512
  v_exp_f32 v32, v32
  v_exp_f32 v33, v33
  v_exp_f32 v34, v34
  v_exp_f32 v35, v35
  v_exp_f32 v36, v36
  v_exp_f32 v37, v37
  v_exp_f32 v38, v38
  v_exp_f32 v39, v39
  v_exp_f32 v40, v40
  v_exp_f32 v41, v41
  v_exp_f32 v42, v42
  v_exp_f32 v43, v43
  v_exp_f32 v44, v44
  v_exp_f32 v45, v45
  v_exp_f32 v46, v46
  v_exp_f32 v47, v47
  v_cvt_pk_bf16_f32 v64, v32, v33
  v_cvt_pk_bf16_f32 v65, v34, v35
  v_cvt_pk_bf16_f32 v66, v36, v37
  v_cvt_pk_bf16_f32 v67, v38, v39
  v_cvt_pk_bf16_f32 v68, v40, v41
  v_cvt_pk_bf16_f32 v69, v42, v43
  v_cvt_pk_bf16_f32 v70, v44, v45
  v_cvt_pk_bf16_f32 v71, v46, v47
  v_mfma_f32_32x32x16_bf16 v[72:87], v[16:19], v[64:67], v[72:87]
  s_nop 0
  v_mfma_f32_32x32x16_bf16 v[72:87], v[20:23], v[68:71], v[72:87]
A2_38_B1:
  s_waitcnt lgkmcnt(0)
  s_add_u32 s65, s62, 65536
  s_add_u32 m0, s51, 73728
  s_nop 0
  buffer_load_dwordx4 v148, s[28:31], s65 offen lds
  v_mfma_f32_32x32x16_bf16 v[32:47], v[8:11], v[4:7], v[120:135]
  ds_read_b128 v[12:15], v140 offset:3072
  v_add_u32 v143, v143, v144
  ds_read_b128 v[16:19], v143
  ds_read_b128 v[20:23], v143 offset:512
  v_exp_f32 v48, v48
  v_exp_f32 v49, v49
  v_exp_f32 v50, v50
  v_exp_f32 v51, v51
  v_exp_f32 v52, v52
  v_exp_f32 v53, v53
  v_exp_f32 v54, v54
  v_exp_f32 v55, v55
  v_exp_f32 v56, v56
  v_exp_f32 v57, v57
  v_exp_f32 v58, v58
  v_exp_f32 v59, v59
  v_exp_f32 v60, v60
  v_exp_f32 v61, v61
  v_exp_f32 v62, v62
  v_exp_f32 v63, v63
  v_cvt_pk_bf16_f32 v64, v48, v49
  v_cvt_pk_bf16_f32 v65, v50, v51
  v_cvt_pk_bf16_f32 v66, v52, v53
  v_cvt_pk_bf16_f32 v67, v54, v55
  v_cvt_pk_bf16_f32 v68, v56, v57
  v_cvt_pk_bf16_f32 v69, v58, v59
  v_cvt_pk_bf16_f32 v70, v60, v61
  v_cvt_pk_bf16_f32 v71, v62, v63
  v_mfma_f32_32x32x16_bf16 v[72:87], v[24:27], v[64:67], v[72:87]
  s_nop 0
  v_mfma_f32_32x32x16_bf16 v[72:87], v[28:31], v[68:71], v[72:87]
A2_38_B2:
  s_waitcnt lgkmcnt(0)
  s_add_u32 s65, s62, 131072
  s_add_u32 m0, s51, 81920
  s_nop 0
  buffer_load_dwordx4 v148, s[28:31], s65 offen lds
  s_add_u32 s65, s64, 1024
  buffer_load_dwordx4 v[240:243], v145, s[36:39], s65 offen sc1
  v_mfma_f32_32x32x16_bf16 v[48:63], v[12:15], v[4:7], v[120:135]
  ds_read_b128 v[8:11], v140 offset:4096
  v_add_u32 v143, v143, v144
  ds_read_b128 v[24:27], v143
  ds_read_b128 v[28:31], v143 offset:512
  v_exp_f32 v32, v32
  v_exp_f32 v33, v33
  v_exp_f32 v34, v34
  v_exp_f32 v35, v35
  v_exp_f32 v36, v36
  v_exp_f32 v37, v37
  v_exp_f32 v38, v38
  v_exp_f32 v39, v39
  v_exp_f32 v40, v40
  v_exp_f32 v41, v41
  v_exp_f32 v42, v42
  v_exp_f32 v43, v43
  v_exp_f32 v44, v44
  v_exp_f32 v45, v45
  v_exp_f32 v46, v46
  v_exp_f32 v47, v47
  v_cvt_pk_bf16_f32 v64, v32, v33
  v_cvt_pk_bf16_f32 v65, v34, v35
  v_cvt_pk_bf16_f32 v66, v36, v37
  v_cvt_pk_bf16_f32 v67, v38, v39
  v_cvt_pk_bf16_f32 v68, v40, v41
  v_cvt_pk_bf16_f32 v69, v42, v43
  v_cvt_pk_bf16_f32 v70, v44, v45
  v_cvt_pk_bf16_f32 v71, v46, v47
  v_mfma_f32_32x32x16_bf16 v[72:87], v[16:19], v[64:67], v[72:87]
  s_nop 0
  v_mfma_f32_32x32x16_bf16 v[72:87], v[20:23], v[68:71], v[72:87]
A2_38_B3:
  s_waitcnt lgkmcnt(0)
  s_add_u32 s65, s62, 196608
  s_add_u32 m0, s51, 90112
  s_nop 0
  buffer_load_dwordx4 v148, s[28:31], s65 offen lds
  v_mfma_f32_32x32x16_bf16 v[32:47], v[8:11], v[4:7], v[120:135]
  ds_read_b128 v[12:15], v140 offset:5120
  v_add_u32 v143, v143, v144
  ds_read_b128 v[16:19], v143
  ds_read_b128 v[20:23], v143 offset:512
  v_exp_f32 v48, v48
  v_exp_f32 v49, v49
  v_exp_f32 v50, v50
  v_exp_f32 v51, v51
  v_exp_f32 v52, v52
  v_exp_f32 v53, v53
  v_exp_f32 v54, v54
  v_exp_f32 v55, v55
  v_exp_f32 v56, v56
  v_exp_f32 v57, v57
  v_exp_f32 v58, v58
  v_exp_f32 v59, v59
  v_exp_f32 v60, v60
  v_exp_f32 v61, v61
  v_exp_f32 v62, v62
  v_exp_f32 v63, v63
  v_cvt_pk_bf16_f32 v64, v48, v49
  v_cvt_pk_bf16_f32 v65, v50, v51
  v_cvt_pk_bf16_f32 v66, v52, v53
  v_cvt_pk_bf16_f32 v67, v54, v55
  v_cvt_pk_bf16_f32 v68, v56, v57
  v_cvt_pk_bf16_f32 v69, v58, v59
  v_cvt_pk_bf16_f32 v70, v60, v61
  v_cvt_pk_bf16_f32 v71, v62, v63
  v_mfma_f32_32x32x16_bf16 v[72:87], v[24:27], v[64:67], v[72:87]
  s_nop 0
  v_mfma_f32_32x32x16_bf16 v[72:87], v[28:31], v[68:71], v[72:87]
A2_38_B4:
  s_waitcnt lgkmcnt(0)
  s_add_u32 s65, s62, 262144
  s_add_u32 m0, s51, 98304
  s_nop 0
  buffer_load_dwordx4 v148, s[28:31], s65 offen lds
  s_add_u32 s65, s64, 2048
  buffer_load_dwordx4 v[240:243], v145, s[36:39], s65 offen sc1
  v_mfma_f32_32x32x16_bf16 v[48:63], v[12:15], v[4:7], v[120:135]
  ds_read_b128 v[8:11], v140 offset:6144
  v_add_u32 v143, v143, v144
  ds_read_b128 v[24:27], v143
  ds_read_b128 v[28:31], v143 offset:512
  v_exp_f32 v32, v32
  v_exp_f32 v33, v33
  v_exp_f32 v34, v34
  v_exp_f32 v35, v35
  v_exp_f32 v36, v36
  v_exp_f32 v37, v37
  v_exp_f32 v38, v38
  v_exp_f32 v39, v39
  v_exp_f32 v40, v40
  v_exp_f32 v41, v41
  v_exp_f32 v42, v42
  v_exp_f32 v43, v43
  v_exp_f32 v44, v44
  v_exp_f32 v45, v45
  v_exp_f32 v46, v46
  v_exp_f32 v47, v47
  v_cvt_pk_bf16_f32 v64, v32, v33
  v_cvt_pk_bf16_f32 v65, v34, v35
  v_cvt_pk_bf16_f32 v66, v36, v37
  v_cvt_pk_bf16_f32 v67, v38, v39
  v_cvt_pk_bf16_f32 v68, v40, v41
  v_cvt_pk_bf16_f32 v69, v42, v43
  v_cvt_pk_bf16_f32 v70, v44, v45
  v_cvt_pk_bf16_f32 v71, v46, v47
  v_mfma_f32_32x32x16_bf16 v[72:87], v[16:19], v[64:67], v[72:87]
  s_nop 0
  v_mfma_f32_32x32x16_bf16 v[72:87], v[20:23], v[68:71], v[72:87]
A2_38_B5:
  s_waitcnt lgkmcnt(0)
  s_add_u32 s65, s62, 327680
  s_add_u32 m0, s51, 106496
  s_nop 0
  buffer_load_dwordx4 v148, s[28:31], s65 offen lds
  s_add_u32 s65, s64, 3072
  buffer_load_dwordx4 v[240:243], v145, s[36:39], s65 offen sc1
  v_mfma_f32_32x32x16_bf16 v[32:47], v[8:11], v[4:7], v[120:135]
  ds_read_b128 v[12:15], v140 offset:7168
  v_add_u32 v143, v143, v144
  ds_read_b128 v[16:19], v143
  ds_read_b128 v[20:23], v143 offset:512
  v_exp_f32 v48, v48
  v_exp_f32 v49, v49
  v_exp_f32 v50, v50
  v_exp_f32 v51, v51
  v_exp_f32 v52, v52
  v_exp_f32 v53, v53
  v_exp_f32 v54, v54
  v_exp_f32 v55, v55
  v_exp_f32 v56, v56
  v_exp_f32 v57, v57
  v_exp_f32 v58, v58
  v_exp_f32 v59, v59
  v_exp_f32 v60, v60
  v_exp_f32 v61, v61
  v_exp_f32 v62, v62
  v_exp_f32 v63, v63
  v_cvt_pk_bf16_f32 v64, v48, v49
  v_cvt_pk_bf16_f32 v65, v50, v51
  v_cvt_pk_bf16_f32 v66, v52, v53
  v_cvt_pk_bf16_f32 v67, v54, v55
  v_cvt_pk_bf16_f32 v68, v56, v57
  v_cvt_pk_bf16_f32 v69, v58, v59
  v_cvt_pk_bf16_f32 v70, v60, v61
  v_cvt_pk_bf16_f32 v71, v62, v63
  v_mfma_f32_32x32x16_bf16 v[72:87], v[24:27], v[64:67], v[72:87]
  s_nop 0
  v_mfma_f32_32x32x16_bf16 v[72:87], v[28:31], v[68:71], v[72:87]
A2_38_B6:
  s_waitcnt lgkmcnt(0)
  s_add_u32 s65, s62, 393216
  s_add_u32 m0, s51, 114688
  s_nop 0
  buffer_load_dwordx4 v148, s[28:31], s65 offen lds
  s_add_u32 s65, s62, 458752
  s_add_u32 m0, s51, 122880
  s_nop 0
  buffer_load_dwordx4 v148, s[28:31], s65 offen lds
  v_mfma_f32_32x32x16_bf16 v[48:63], v[12:15], v[4:7], v[120:135]
  ds_read_b128 v[8:11], v140 offset:8192
  v_add_u32 v143, v143, v144
  ds_read_b128 v[24:27], v143
  ds_read_b128 v[28:31], v143 offset:512
  v_exp_f32 v32, v32
  v_exp_f32 v33, v33
  v_exp_f32 v34, v34
  v_exp_f32 v35, v35
  v_exp_f32 v36, v36
  v_exp_f32 v37, v37
  v_exp_f32 v38, v38
  v_exp_f32 v39, v39
  v_exp_f32 v40, v40
  v_exp_f32 v41, v41
  v_exp_f32 v42, v42
  v_exp_f32 v43, v43
  v_exp_f32 v44, v44
  v_exp_f32 v45, v45
  v_exp_f32 v46, v46
  v_exp_f32 v47, v47
  v_cvt_pk_bf16_f32 v64, v32, v33
  v_cvt_pk_bf16_f32 v65, v34, v35
  v_cvt_pk_bf16_f32 v66, v36, v37
  v_cvt_pk_bf16_f32 v67, v38, v39
  v_cvt_pk_bf16_f32 v68, v40, v41
  v_cvt_pk_bf16_f32 v69, v42, v43
  v_cvt_pk_bf16_f32 v70, v44, v45
  v_cvt_pk_bf16_f32 v71, v46, v47
  v_mfma_f32_32x32x16_bf16 v[72:87], v[16:19], v[64:67], v[72:87]
  s_nop 0
  v_mfma_f32_32x32x16_bf16 v[72:87], v[20:23], v[68:71], v[72:87]
A2_38_B7:
  s_waitcnt lgkmcnt(0)
  v_mfma_f32_32x32x16_bf16 v[32:47], v[8:11], v[4:7], v[104:119]
  v_add_u32 v143, v143, v144
  ds_read_b128 v[16:19], v143
  ds_read_b128 v[20:23], v143 offset:512
  s_nop 4
  v_exp_f32 v48, v48
  v_exp_f32 v49, v49
  v_exp_f32 v50, v50
  v_exp_f32 v51, v51
  v_exp_f32 v52, v52
  v_exp_f32 v53, v53
  v_exp_f32 v54, v54
  v_exp_f32 v55, v55
  v_exp_f32 v56, v56
  v_exp_f32 v57, v57
  v_exp_f32 v58, v58
  v_exp_f32 v59, v59
  v_exp_f32 v60, v60
  v_exp_f32 v61, v61
  v_exp_f32 v62, v62
  v_exp_f32 v63, v63
  v_cvt_pk_bf16_f32 v64, v48, v49
  v_cvt_pk_bf16_f32 v65, v50, v51
  v_cvt_pk_bf16_f32 v66, v52, v53
  v_cvt_pk_bf16_f32 v67, v54, v55
  v_cvt_pk_bf16_f32 v68, v56, v57
  v_cvt_pk_bf16_f32 v69, v58, v59
  v_cvt_pk_bf16_f32 v70, v60, v61
  v_cvt_pk_bf16_f32 v71, v62, v63
  v_mfma_f32_32x32x16_bf16 v[72:87], v[24:27], v[64:67], v[72:87]
  s_nop 0
  v_mfma_f32_32x32x16_bf16 v[72:87], v[28:31], v[68:71], v[72:87]
A2_38_B8:
  s_waitcnt lgkmcnt(0)
  s_nop 9
  v_exp_f32 v32, v32
  v_exp_f32 v33, v33
  v_exp_f32 v34, v34
  v_exp_f32 v35, v35
  v_exp_f32 v36, v36
  v_exp_f32 v37, v37
  v_exp_f32 v38, v38
  v_exp_f32 v39, v39
  v_exp_f32 v40, v40
  v_exp_f32 v41, v41
  v_exp_f32 v42, v42
  v_exp_f32 v43, v43
  v_exp_f32 v44, v44
  v_exp_f32 v45, v45
  v_exp_f32 v46, v46
  v_exp_f32 v47, v47
  v_cvt_pk_bf16_f32 v64, v32, v33
  v_cvt_pk_bf16_f32 v65, v34, v35
  v_cvt_pk_bf16_f32 v66, v36, v37
  v_cvt_pk_bf16_f32 v67, v38, v39
  v_cvt_pk_bf16_f32 v68, v40, v41
  v_cvt_pk_bf16_f32 v69, v42, v43
  v_cvt_pk_bf16_f32 v70, v44, v45
  v_cvt_pk_bf16_f32 v71, v46, v47
  v_mfma_f32_32x32x16_bf16 v[72:87], v[16:19], v[64:67], v[72:87]
  s_nop 0
  v_mfma_f32_32x32x16_bf16 v[72:87], v[20:23], v[68:71], v[72:87]
  s_cmp_lg_u32 s7, 0
  s_cbranch_scc1 Ldone_36
  v_mov_b32 v139, 0x1f800000
  s_nop 8
  v_cmp_nge_f32 vcc, v80, v139
  s_cbranch_vccz Ldone_36
  v_mov_b32 v136, 0xf149f2ca
  v_fmaak_f32 v120, v151, v136, 0x00000000
  v_fmaak_f32 v121, v151, v136, 0x7149f2ca
  v_fmaak_f32 v122, v151, v136, 0x71c9f2ca
  v_fmaak_f32 v123, v151, v136, 0x72177617
  v_fmaak_f32 v124, v151, v136, 0x72c9f2ca
  v_fmaak_f32 v125, v151, v136, 0x72e33123
  v_fmaak_f32 v126, v151, v136, 0x72fc6f7c
  v_fmaak_f32 v127, v151, v136, 0x730ad6eb
  v_fmaak_f32 v128, v151, v136, 0x7349f2ca
  v_fmaak_f32 v129, v151, v136, 0x735691f6
  v_fmaak_f32 v130, v151, v136, 0x73633123
  v_fmaak_f32 v131, v151, v136, 0x736fd050
  v_fmaak_f32 v132, v151, v136, 0x73977617
  v_fmaak_f32 v133, v151, v136, 0x739dc5ae
  v_fmaak_f32 v134, v151, v136, 0x73a41544
  v_fmaak_f32 v135, v151, v136, 0x73aa64da
  v_min_f32 v88, 0, v120
  v_min_f32_e64 v104, 0, -v120
  v_min_f32 v89, 0, v121
  v_min_f32_e64 v105, 0, -v121
  v_min_f32 v90, 0, v122
  v_min_f32_e64 v106, 0, -v122
  v_min_f32 v91, 0, v123
  v_min_f32_e64 v107, 0, -v123
  v_min_f32 v92, 0, v124
  v_min_f32_e64 v108, 0, -v124
  v_min_f32 v93, 0, v125
  v_min_f32_e64 v109, 0, -v125
  v_min_f32 v94, 0, v126
  v_min_f32_e64 v110, 0, -v126
  v_min_f32 v95, 0, v127
  v_min_f32_e64 v111, 0, -v127
  v_min_f32 v96, 0, v128
  v_min_f32_e64 v112, 0, -v128
  v_min_f32 v97, 0, v129
  v_min_f32_e64 v113, 0, -v129
  v_min_f32 v98, 0, v130
  v_min_f32_e64 v114, 0, -v130
  v_min_f32 v99, 0, v131
  v_min_f32_e64 v115, 0, -v131
  v_min_f32 v100, 0, v132
  v_min_f32_e64 v116, 0, -v132
  v_min_f32 v101, 0, v133
  v_min_f32_e64 v117, 0, -v133
  v_min_f32 v102, 0, v134
  v_min_f32_e64 v118, 0, -v134
  v_min_f32 v103, 0, v135
  v_min_f32_e64 v119, 0, -v135
  v_mov_b64 v[72:73], 0
  v_mov_b64 v[74:75], 0
  v_mov_b64 v[76:77], 0
  v_mov_b64 v[78:79], 0
  v_mov_b64 v[80:81], 0
  v_mov_b64 v[82:83], 0
  v_mov_b64 v[84:85], 0
  v_mov_b64 v[86:87], 0
  v_mov_b32 v136, 0xf149f2ca
  v_mov_b32 v137, 0xf149f2ca
  s_cmp_eq_u32 s59, 8
  s_cbranch_scc1 A1_39_E8
  s_cmp_eq_u32 s59, 7
  s_cbranch_scc1 A1_39_E7
  s_cmp_eq_u32 s59, 6
  s_cbranch_scc1 A1_39_E6
  s_cmp_eq_u32 s59, 5
  s_cbranch_scc1 A1_39_E5
  s_cmp_eq_u32 s59, 4
  s_cbranch_scc1 A1_39_E4
  s_cmp_eq_u32 s59, 3
  s_cbranch_scc1 A1_39_E3
  s_cmp_eq_u32 s59, 2
  s_cbranch_scc1 A1_39_E2
  s_cmp_eq_u32 s59, 1
  s_cbranch_scc1 A1_39_E1
  ds_read_b128 v[8:11], v140 offset:0
  s_waitcnt lgkmcnt(0)
  v_mfma_f32_32x32x16_bf16 v[32:47], v[8:11], v[4:7], v[88:103]
  ds_read_b128 v[12:15], v140 offset:1024
  s_branch A1_39_B0
A1_39_E1:
  ds_read_b128 v[12:15], v140 offset:1024
  s_waitcnt lgkmcnt(0)
  v_mfma_f32_32x32x16_bf16 v[48:63], v[12:15], v[4:7], 0
  ds_read_b128 v[8:11], v140 offset:2048
  s_branch A1_39_B1
A1_39_E2:
  ds_read_b128 v[8:11], v140 offset:2048
  s_waitcnt lgkmcnt(0)
  v_mfma_f32_32x32x16_bf16 v[32:47], v[8:11], v[4:7], 0
  ds_read_b128 v[12:15], v140 offset:3072
  s_branch A1_39_B2
A1_39_E3:
  ds_read_b128 v[12:15], v140 offset:3072
  s_waitcnt lgkmcnt(0)
  v_mfma_f32_32x32x16_bf16 v[48:63], v[12:15], v[4:7], 0
  ds_read_b128 v[8:11], v140 offset:4096
  s_branch A1_39_B3
A1_39_E4:
  ds_read_b128 v[8:11], v140 offset:4096
  s_waitcnt lgkmcnt(0)
  v_mfma_f32_32x32x16_bf16 v[32:47], v[8:11], v[4:7], 0
  ds_read_b128 v[12:15], v140 offset:5120
  s_branch A1_39_B4
A1_39_E5:
  ds_read_b128 v[12:15], v140 offset:5120
  s_waitcnt lgkmcnt(0)
  v_mfma_f32_32x32x16_bf16 v[48:63], v[12:15], v[4:7], 0
  ds_read_b128 v[8:11], v140 offset:6144
  s_branch A1_39_B5
A1_39_E6:
  ds_read_b128 v[8:11], v140 offset:6144
  s_waitcnt lgkmcnt(0)
  v_mfma_f32_32x32x16_bf16 v[32:47], v[8:11], v[4:7], 0
  ds_read_b128 v[12:15], v140 offset:7168
  s_branch A1_39_B6
A1_39_E7:
  ds_read_b128 v[12:15], v140 offset:7168
  s_waitcnt lgkmcnt(0)
  v_mfma_f32_32x32x16_bf16 v[48:63], v[12:15], v[4:7], 0
  ds_read_b128 v[8:11], v140 offset:8192
  s_branch A1_39_B7
A1_39_E8:
  ds_read_b128 v[8:11], v140 offset:8192
  s_waitcnt lgkmcnt(0)
  v_mfma_f32_32x32x16_bf16 v[32:47], v[8:11], v[4:7], v[104:119]
  s_branch A1_39_B8
A1_39_B0:
  s_waitcnt lgkmcnt(0)
  v_mfma_f32_32x32x16_bf16 v[48:63], v[12:15], v[4:7], 0
  ds_read_b128 v[8:11], v140 offset:2048
  s_nop 6
  v_max3_f32 v136, v32, v33, v136
  v_max3_f32 v137, v34, v35, v137
  v_max3_f32 v136, v36, v37, v136
  v_max3_f32 v137, v38, v39, v137
  v_max3_f32 v136, v40, v41, v136
  v_max3_f32 v137, v42, v43, v137
  v_max3_f32 v136, v44, v45, v136
  v_max3_f32 v137, v46, v47, v137
A1_39_B1:
  s_waitcnt lgkmcnt(0)
  v_mfma_f32_32x32x16_bf16 v[32:47], v[8:11], v[4:7], 0
  ds_read_b128 v[12:15], v140 offset:3072
  s_nop 6
  v_max3_f32 v136, v48, v49, v136
  v_max3_f32 v137, v50, v51, v137
  v_max3_f32 v136, v52, v53, v136
  v_max3_f32 v137, v54, v55, v137
  v_max3_f32 v136, v56, v57, v136
  v_max3_f32 v137, v58, v59, v137
  v_max3_f32 v136, v60, v61, v136
  v_max3_f32 v137, v62, v63, v137
A1_39_B2:
  s_waitcnt lgkmcnt(0)
  v_mfma_f32_32x32x16_bf16 v[48:63], v[12:15], v[4:7], 0
  ds_read_b128 v[8:11], v140 offset:4096
  s_nop 6
  v_max3_f32 v136, v32, v33, v136
  v_max3_f32 v137, v34, v35, v137
  v_max3_f32 v136, v36, v37, v136
  v_max3_f32 v137, v38, v39, v137
  v_max3_f32 v136, v40, v41, v136
  v_max3_f32 v137, v42, v43, v137
  v_max3_f32 v136, v44, v45, v136
  v_max3_f32 v137, v46, v47, v137
A1_39_B3:
  s_waitcnt lgkmcnt(0)
  v_mfma_f32_32x32x16_bf16 v[32:47], v[8:11], v[4:7], 0
  ds_read_b128 v[12:15], v140 offset:5120
  s_nop 6
  v_max3_f32 v136, v48, v49, v136
  v_max3_f32 v137, v50, v51, v137
  v_max3_f32 v136, v52, v53, v136
  v_max3_f32 v137, v54, v55, v137
  v_max3_f32 v136, v56, v57, v136
  v_max3_f32 v137, v58, v59, v137
  v_max3_f32 v136, v60, v61, v136
  v_max3_f32 v137, v62, v63, v137
A1_39_B4:
  s_waitcnt lgkmcnt(0)
  v_mfma_f32_32x32x16_bf16 v[48:63], v[12:15], v[4:7], 0
  ds_read_b128 v[8:11], v140 offset:6144
  s_nop 6
  v_max3_f32 v136, v32, v33, v136
  v_max3_f32 v137, v34, v35, v137
  v_max3_f32 v136, v36, v37, v136
  v_max3_f32 v137, v38, v39, v137
  v_max3_f32 v136, v40, v41, v136
  v_max3_f32 v137, v42, v43, v137
  v_max3_f32 v136, v44, v45, v136
  v_max3_f32 v137, v46, v47, v137
A1_39_B5:
  s_waitcnt lgkmcnt(0)
  v_mfma_f32_32x32x16_bf16 v[32:47], v[8:11], v[4:7], 0
  ds_read_b128 v[12:15], v140 offset:7168
  s_nop 6
  v_max3_f32 v136, v48, v49, v136
  v_max3_f32 v137, v50, v51, v137
  v_max3_f32 v136, v52, v53, v136
  v_max3_f32 v137, v54, v55, v137
  v_max3_f32 v136, v56, v57, v136
  v_max3_f32 v137, v58, v59, v137
  v_max3_f32 v136, v60, v61, v136
  v_max3_f32 v137, v62, v63, v137
A1_39_B6:
  s_waitcnt lgkmcnt(0)
  v_mfma_f32_32x32x16_bf16 v[48:63], v[12:15], v[4:7], 0
  ds_read_b128 v[8:11], v140 offset:8192
  s_nop 6
  v_max3_f32 v136, v32, v33, v136
  v_max3_f32 v137, v34, v35, v137
  v_max3_f32 v136, v36, v37, v136
  v_max3_f32 v137, v38, v39, v137
  v_max3_f32 v136, v40, v41, v136
  v_max3_f32 v137, v42, v43, v137
  v_max3_f32 v136, v44, v45, v136
  v_max3_f32 v137, v46, v47, v137
A1_39_B7:
  s_waitcnt lgkmcnt(0)
  v_mfma_f32_32x32x16_bf16 v[32:47], v[8:11], v[4:7], v[104:119]
  s_nop 7
  v_max3_f32 v136, v48, v49, v136
  v_max3_f32 v137, v50, v51, v137
  v_max3_f32 v136, v52, v53, v136
  v_max3_f32 v137, v54, v55, v137
  v_max3_f32 v136, v56, v57, v136
  v_max3_f32 v137, v58, v59, v137
  v_max3_f32 v136, v60, v61, v136
  v_max3_f32 v137, v62, v63, v137
A1_39_B8:
  s_nop 10
  v_max3_f32 v136, v32, v33, v136
  s_nop 9
  v_max3_f32 v137, v34, v35, v137
  v_max3_f32 v136, v36, v37, v136
  v_max3_f32 v137, v38, v39, v137
  v_max3_f32 v136, v40, v41, v136
  v_max3_f32 v137, v42, v43, v137
  v_max3_f32 v136, v44, v45, v136
  v_max3_f32 v137, v46, v47, v137
  v_max_f32 v136, v136, v137
  v_mov_b32 v138, v136
  s_nop 1
  v_permlane32_swap_b32 v136, v138
  v_max_f32 v136, v136, v138
  v_pk_add_f32 v[88:89], v[88:89], v[136:137] op_sel_hi:[1,0] neg_lo:[0,1] neg_hi:[0,1]
  v_pk_add_f32 v[104:105], v[104:105], v[136:137] op_sel_hi:[1,0] neg_lo:[0,1] neg_hi:[0,1]
  v_pk_add_f32 v[90:91], v[90:91], v[136:137] op_sel_hi:[1,0] neg_lo:[0,1] neg_hi:[0,1]
  v_pk_add_f32 v[106:107], v[106:107], v[136:137] op_sel_hi:[1,0] neg_lo:[0,1] neg_hi:[0,1]
  v_pk_add_f32 v[92:93], v[92:93], v[136:137] op_sel_hi:[1,0] neg_lo:[0,1] neg_hi:[0,1]
  v_pk_add_f32 v[108:109], v[108:109], v[136:137] op_sel_hi:[1,0] neg_lo:[0,1] neg_hi:[0,1]
  v_pk_add_f32 v[94:95], v[94:95], v[136:137] op_sel_hi:[1,0] neg_lo:[0,1] neg_hi:[0,1]
  v_pk_add_f32 v[110:111], v[110:111], v[136:137] op_sel_hi:[1,0] neg_lo:[0,1] neg_hi:[0,1]
  v_pk_add_f32 v[96:97], v[96:97], v[136:137] op_sel_hi:[1,0] neg_lo:[0,1] neg_hi:[0,1]
  v_pk_add_f32 v[112:113], v[112:113], v[136:137] op_sel_hi:[1,0] neg_lo:[0,1] neg_hi:[0,1]
  v_pk_add_f32 v[98:99], v[98:99], v[136:137] op_sel_hi:[1,0] neg_lo:[0,1] neg_hi:[0,1]
  v_pk_add_f32 v[114:115], v[114:115], v[136:137] op_sel_hi:[1,0] neg_lo:[0,1] neg_hi:[0,1]
  v_pk_add_f32 v[100:101], v[100:101], v[136:137] op_sel_hi:[1,0] neg_lo:[0,1] neg_hi:[0,1]
  v_pk_add_f32 v[116:117], v[116:117], v[136:137] op_sel_hi:[1,0] neg_lo:[0,1] neg_hi:[0,1]
  v_pk_add_f32 v[102:103], v[102:103], v[136:137] op_sel_hi:[1,0] neg_lo:[0,1] neg_hi:[0,1]
  v_pk_add_f32 v[118:119], v[118:119], v[136:137] op_sel_hi:[1,0] neg_lo:[0,1] neg_hi:[0,1]
  v_sub_f32 v120, 0, v136
  v_mov_b32 v121, v120
  v_mov_b64 v[122:123], v[120:121]
  v_mov_b64 v[124:125], v[120:121]
  v_mov_b64 v[126:127], v[120:121]
  v_mov_b64 v[128:129], v[120:121]
  v_mov_b64 v[130:131], v[120:121]
  v_mov_b64 v[132:133], v[120:121]
  v_mov_b64 v[134:135], v[120:121]
  s_mov_b32 s7, 1
  s_branch Lmain_35
Ldone_36:
  s_nop 9
  v_rcp_f32 v138, v80
  s_nop 0
  v_mul_f32 v72, v72, v138
  v_mul_f32 v73, v73, v138
  v_mul_f32 v74, v74, v138
  v_mul_f32 v75, v75, v138
  v_mul_f32 v76, v76, v138
  v_mul_f32 v77, v77, v138
  v_mul_f32 v78, v78, v138
  v_mul_f32 v79, v79, v138
  v_cvt_pk_bf16_f32 v64, v72, v73
  v_cvt_pk_bf16_f32 v65, v74, v75
  v_cvt_pk_bf16_f32 v66, v76, v77
  v_cvt_pk_bf16_f32 v67, v78, v79
  v_and_b32 v2, 31, v1
  v_lshrrev_b32 v3, 5, v1
  s_lshl_b32 s54, s53, 1
  v_add_u32 v3, s54, v3
  v_bfe_u32 v4, v2, 1, 2
  v_xor_b32 v3, v3, v4
  v_lshlrev_b32 v3, 4, v3
  v_lshl_add_u32 v3, v2, 6, v3
  s_lshl_b32 s54, s52, 11
  s_add_u32 s54, s54, 49152
  v_add_u32 v3, s54, v3
  ds_write_b128 v3, v[64:67]
  v_lshrrev_b32 v2, 2, v0
  v_bfe_u32 v4, v2, 1, 2
  v_xor_b32 v3, v4, v0
  v_and_b32 v3, 3, v3
  v_lshlrev_b32 v3, 4, v3
  v_lshl_add_u32 v3, v2, 6, v3
  v_add_u32 v3, 49152, v3
  v_lshrrev_b32 v4, 6, v2
  v_lshlrev_b32 v4, 16, v4
  v_and_b32 v2, 63, v2
  v_lshl_add_u32 v4, v2, 7, v4
  v_and_b32 v2, 3, v0
  v_lshl_add_u32 v4, v2, 4, v4
  s_lshl_b32 s54, s5, 17
  s_lshr_b32 s55, s6, 1
  s_lshl_b32 s55, s55, 13
  s_add_u32 s54, s54, s55
  s_and_b32 s55, s6, 1
  s_lshl_b32 s55, s55, 6
  s_add_u32 s54, s54, s55
  s_lshl_b32 s58, s5, 4
  s_add_u32 s58, s58, s6
  s_waitcnt lgkmcnt(0)
  s_barrier
  ds_read_b128 v[64:67], v3
  s_waitcnt lgkmcnt(0)
  buffer_store_dwordx4 v[64:67], v4, s[40:43], s54 offen sc1
  s_mov_b32 s14, s58
  s_lshr_b32 s7, s48, 2
  s_bfe_u32 s52, s48, 0x10001
  s_and_b32 s53, s48, 1
  s_lshl_b32 s62, s50, 7
  s_and_b32 s59, s49, 3
  s_mul_i32 s59, s59, 2
  v_lshrrev_b32 v2, 3, v1
  v_and_b32 v3, 7, v1
  v_xor_b32 v3, v2, v3
  v_lshlrev_b32 v3, 4, v3
  s_lshl_b32 s54, s48, 3
  v_add_u32 v2, s54, v2
  s_mov_b32 s54, 128
  v_mul_lo_u32 v2, v2, s54
  v_add_u32 v10, v2, v3
  s_lshl_b32 s57, s52, 12
  v_and_b32 v2, 15, v1
  v_lshrrev_b32 v3, 4, v1
  v_and_b32 v4, 7, v2
  v_xor_b32 v3, v3, v4
  v_lshlrev_b32 v3, 4, v3
  v_lshl_add_u32 v12, v2, 7, v3
  v_add_u32 v12, s57, v12
  v_xor_b32 v18, 64, v12
  s_cmp_eq_u32 s7, 1
  s_cselect_b32 s54, 64, 0
  v_xor_b32 v12, s54, v12
  v_add_u32 v13, 0x10000, v12
  s_lshl_b32 s55, s53, 1
  s_add_u32 s55, s55, 0
  v_lshrrev_b32 v2, 4, v1
  v_bfe_u32 v3, v1, 2, 2
  v_lshl_add_u32 v14, v2, 3, v3
  v_lshlrev_b32 v14, 7, v14
  v_bfe_u32 v3, v1, 3, 1
  v_and_b32 v2, 1, v2
  v_lshl_add_u32 v3, v2, 1, v3
  v_xor_b32 v3, s55, v3
  v_lshl_add_u32 v14, v3, 5, v14
  v_and_b32 v4, 3, v1
  v_lshl_add_u32 v14, v4, 3, v14
  s_lshl_b32 s54, s7, 12
  v_add_u32 v14, s54, v14
  v_add_u32 v16, 0x10000, v14
  s_lshl_b32 s55, s53, 1
  s_add_u32 s55, s55, 1
  v_lshrrev_b32 v2, 4, v1
  v_bfe_u32 v3, v1, 2, 2
  v_lshl_add_u32 v15, v2, 3, v3
  v_lshlrev_b32 v15, 7, v15
  v_bfe_u32 v3, v1, 3, 1
  v_and_b32 v2, 1, v2
  v_lshl_add_u32 v3, v2, 1, v3
  v_xor_b32 v3, s55, v3
  v_lshl_add_u32 v15, v3, 5, v15
  v_and_b32 v4, 3, v1
  v_lshl_add_u32 v15, v4, 3, v15
  s_lshl_b32 s54, s7, 12
  v_add_u32 v15, s54, v15
  v_add_u32 v17, 0x10000, v15
  v_mov_b32 v20, 0
  v_mov_b32 v21, 0
  v_mov_b32 v22, 0
  v_mov_b32 v23, 0
  v_mov_b32 v24, 0
  v_mov_b32 v25, 0
  v_mov_b32 v26, 0
  v_mov_b32 v27, 0
  v_mov_b32 v28, 0
  v_mov_b32 v29, 0
  v_mov_b32 v30, 0
  v_mov_b32 v31, 0
  v_mov_b32 v32, 0
  v_mov_b32 v33, 0
  v_mov_b32 v34, 0
  v_mov_b32 v35, 0
  s_add_u32 s28, s26, 6291456
  s_addc_u32 s29, s27, 0
  s_mov_b32 s30, 2097152
  s_mov_b32 s31, 0x20000
  s_mov_b32 s36, s8
  s_mov_b32 s37, s9
  s_mov_b32 s38, 2097152
  s_mov_b32 s39, 0x20000
  s_add_u32 s40, s26, 8388608
  s_addc_u32 s41, s27, 0
  s_mov_b32 s42, 2097152
  s_mov_b32 s43, 0x20000
  s_lshl_b32 s61, s49, 16
  v_lshrrev_b32 v2, 3, v0
  v_and_b32 v3, 7, v0
  v_lshlrev_b32 v2, 10, v2
  v_lshl_add_u32 v8, v3, 4, v2
  s_lshl_b32 s54, s49, 16
  s_lshl_b32 s55, s50, 7
  s_add_u32 s54, s54, s55
  v_add_u32 v8, s54, v8
  s_lshl_b32 s58, s49, 3
  s_add_u32 s58, s58, s50
  s_lshl_b32 s54, s58, 13
  v_lshlrev_b32 v9, 4, v0
  v_add_u32 v9, s54, v9
  v_and_b32 v5, 15, v1
  s_lshr_b32 s54, s49, 1
  s_lshl_b32 s54, s54, 4
  v_add_u32 v5, s54, v5
  v_lshlrev_b32 v5, 7, v5
  v_add_u32 v5, 65536, v5
  v_and_b32 v2, 15, v1
  v_lshrrev_b32 v3, 4, v1
  s_lshl_b32 s54, s7, 14
  s_lshl_b32 s55, s52, 13
  s_add_u32 s54, s54, s55
  s_lshl_b32 s55, s53, 3
  v_add_u32 v4, s55, v3
  v_xor_b32 v4, v4, v2
  v_lshlrev_b32 v4, 4, v4
  v_lshl_add_u32 v4, v2, 8, v4
  v_add_u32 v72, s54, v4
  v_add_u32 v4, s55, v3
  v_add_u32 v4, 4, v4
  v_xor_b32 v4, v4, v2
  v_lshlrev_b32 v4, 4, v4
  v_lshl_add_u32 v4, v2, 8, v4
  v_add_u32 v73, s54, v4
  v_lshrrev_b32 v2, 3, v0
  v_and_b32 v3, 7, v0
  v_lshlrev_b32 v3, 1, v3
  v_and_b32 v4, 15, v2
  v_xor_b32 v3, v3, v4
  v_lshlrev_b32 v3, 4, v3
  v_lshl_add_u32 v74, v2, 8, v3
  v_xor_b32 v75, 16, v74
  s_lshl_b32 s54, s49, 6
  v_add_u32 v2, s54, v2
  v_lshlrev_b32 v2, 6, v2
  v_and_b32 v3, 7, v0
  v_mov_b32 v4, 0x7fffffff
  v_cmp_eq_u32 vcc, 0, v3
  s_nop 1
  v_cndmask_b32 v76, v4, v2, vcc
  s_lshl_b32 s67, s50, 3
  s_waitcnt vmcnt(0)
  s_barrier
  s_cmp_eq_u32 s48, 0
  s_cbranch_scc0 Lsig_40
  s_lshl_b32 s54, s14, 7
  s_add_u32 s54, s54, 65536
  v_mov_b32 v2, s4
  v_mov_b32 v3, 0
  s_mov_b64 exec, 1
  buffer_store_dword v2, v3, s[44:47], s54 offen sc1
  s_mov_b64 exec, -1
Lsig_40:
  s_cmp_ge_u32 s48, 4
  s_cbranch_scc0 Lup_41
  s_add_u32 s32, s26, 19922944
  s_addc_u32 s33, s27, 0
  s_mov_b32 s34, 4194304
  s_mov_b32 s35, 0x20000
  v_lshlrev_b32 v79, 4, v1
  s_sub_u32 s54, s48, 4
  s_lshl_b32 s63, s54, 13
  v_add_u32 v79, s63, v79
  v_add_u32 v78, 4096, v79
  s_lshl_b32 s64, s1, 18
  s_add_u32 m0, s63, 131072
  s_nop 0
  buffer_load_dwordx4 v79, s[32:35], s64 offen sc1 lds
  buffer_load_dwordx4 v79, s[32:35], s64 offen offset:1024 sc1 lds
  buffer_load_dwordx4 v79, s[32:35], s64 offen offset:2048 sc1 lds
  buffer_load_dwordx4 v79, s[32:35], s64 offen offset:3072 sc1 lds
  s_add_u32 m0, s63, 135168
  s_nop 0
  buffer_load_dwordx4 v78, s[32:35], s64 offen sc1 lds
  buffer_load_dwordx4 v78, s[32:35], s64 offen offset:1024 sc1 lds
  buffer_load_dwordx4 v78, s[32:35], s64 offen offset:2048 sc1 lds
  buffer_load_dwordx4 v78, s[32:35], s64 offen offset:3072 sc1 lds
Lup_41:
  s_cmp_eq_u32 s48, 0
  s_cbranch_scc0 Lw_42
  s_mov_b32 s3, 0
Lp_43:
  buffer_load_dword v2, v5, s[44:47], 0 offen sc1
  s_waitcnt vmcnt(0)
  v_cmp_ne_u32 vcc, s4, v2
  s_nop 0
  s_and_b32 s71, vcc_lo, 255
  s_cbranch_scc0 Lo_44
  s_add_u32 s3, s3, 1
  s_cmp_lt_u32 s3, 400000
  s_cbranch_scc1 Lp_43
Lo_44:
Lw_42:
  s_barrier
  s_add_u32 m0, s51, 0
  s_nop 0
  buffer_load_dwordx4 v10, s[28:31], s61 offen sc1 lds
  s_add_u32 s61, s61, 8192
  s_add_u32 m0, s51, 8192
  s_nop 0
  buffer_load_dwordx4 v10, s[28:31], s61 offen sc1 lds
  s_add_u32 s61, s61, 8192
  s_add_u32 m0, s51, 16384
  s_nop 0
  buffer_load_dwordx4 v10, s[28:31], s61 offen sc1 lds
  s_add_u32 s61, s61, 8192
  s_add_u32 m0, s51, 24576
  s_nop 0
  buffer_load_dwordx4 v10, s[28:31], s61 offen sc1 lds
  s_add_u32 s61, s61, 8192
  s_cmp_eq_u32 s48, 0
  s_cbranch_scc0 Lw_45
  s_mov_b32 s3, 0
Lp_46:
  buffer_load_dword v2, v5, s[44:47], 0 offen sc1
  s_waitcnt vmcnt(0)
  v_cmp_ne_u32 vcc, s4, v2
  s_cbranch_vccz Lo_47
  s_add_u32 s3, s3, 1
  s_cmp_lt_u32 s3, 400000
  s_cbranch_scc1 Lp_46
Lo_47:
Lw_45:
  s_waitcnt vmcnt(2)
  s_barrier
  ds_read_b128 v[40:43], v12 offset:0
  ds_read_b128 v[44:47], v12 offset:2048
  ds_read_b64_tr_b16 v[48:49], v16 offset:0
  ds_read_b64_tr_b16 v[50:51], v16 offset:512
  ds_read_b64_tr_b16 v[52:53], v17 offset:0
  ds_read_b64_tr_b16 v[54:55], v17 offset:512
  s_waitcnt lgkmcnt(0)
  v_mfma_f32_16x16x32_bf16 v[20:23], v[48:51], v[40:43], v[20:23]
  ds_read_b128 v[56:59], v12 offset:8192
  ds_read_b128 v[60:63], v12 offset:10240
  s_add_u32 m0, s51, 32768
  s_nop 0
  buffer_load_dwordx4 v10, s[28:31], s61 offen sc1 lds
  s_add_u32 s61, s61, 8192
  v_mfma_f32_16x16x32_bf16 v[24:27], v[48:51], v[44:47], v[24:27]
  ds_read_b64_tr_b16 v[64:65], v16 offset:8192
  ds_read_b64_tr_b16 v[66:67], v16 offset:8704
  s_add_u32 m0, s51, 40960
  s_nop 0
  buffer_load_dwordx4 v10, s[28:31], s61 offen sc1 lds
  s_add_u32 s61, s61, 8192
  v_mfma_f32_16x16x32_bf16 v[28:31], v[52:55], v[40:43], v[28:31]
  ds_read_b64_tr_b16 v[68:69], v17 offset:8192
  ds_read_b64_tr_b16 v[70:71], v17 offset:8704
  s_add_u32 m0, s51, 49152
  s_nop 0
  buffer_load_dwordx4 v10, s[28:31], s61 offen sc1 lds
  s_add_u32 s61, s61, 8192
  s_add_u32 m0, s51, 57344
  s_nop 0
  buffer_load_dwordx4 v10, s[28:31], s61 offen sc1 lds
  s_add_u32 s61, s61, 8192
  v_mfma_f32_16x16x32_bf16 v[32:35], v[52:55], v[44:47], v[32:35]
  buffer_load_dwordx4 v[36:39], v8, s[36:39], 0 offen
  s_add_u32 s36, s26, 10485760
  s_addc_u32 s37, s27, 0
  s_mov_b32 s38, 131072
  s_mov_b32 s39, 0x20000
  s_waitcnt lgkmcnt(0)
  s_waitcnt vmcnt(5)
  s_barrier
  v_mfma_f32_16x16x32_bf16 v[20:23], v[64:67], v[56:59], v[20:23]
  ds_read_b128 v[40:43], v12 offset:16384
  ds_read_b128 v[44:47], v12 offset:18432
  v_mfma_f32_16x16x32_bf16 v[24:27], v[64:67], v[60:63], v[24:27]
  ds_read_b64_tr_b16 v[48:49], v16 offset:16384
  ds_read_b64_tr_b16 v[50:51], v16 offset:16896
  v_mfma_f32_16x16x32_bf16 v[28:31], v[68:71], v[56:59], v[28:31]
  ds_read_b64_tr_b16 v[52:53], v17 offset:16384
  ds_read_b64_tr_b16 v[54:55], v17 offset:16896
  v_mfma_f32_16x16x32_bf16 v[32:35], v[68:71], v[60:63], v[32:35]
  s_waitcnt lgkmcnt(0)
  v_mfma_f32_16x16x32_bf16 v[20:23], v[48:51], v[40:43], v[20:23]
  ds_read_b128 v[56:59], v12 offset:24576
  ds_read_b128 v[60:63], v12 offset:26624
  v_mfma_f32_16x16x32_bf16 v[24:27], v[48:51], v[44:47], v[24:27]
  ds_read_b64_tr_b16 v[64:65], v16 offset:24576
  ds_read_b64_tr_b16 v[66:67], v16 offset:25088
  v_mfma_f32_16x16x32_bf16 v[28:31], v[52:55], v[40:43], v[28:31]
  ds_read_b64_tr_b16 v[68:69], v17 offset:24576
  ds_read_b64_tr_b16 v[70:71], v17 offset:25088
  v_mfma_f32_16x16x32_bf16 v[32:35], v[52:55], v[44:47], v[32:35]
  s_waitcnt lgkmcnt(0)
  s_waitcnt vmcnt(3)
  s_barrier
  v_mfma_f32_16x16x32_bf16 v[20:23], v[64:67], v[56:59], v[20:23]
  ds_read_b128 v[40:43], v12 offset:32768
  ds_read_b128 v[44:47], v12 offset:34816
  v_mfma_f32_16x16x32_bf16 v[24:27], v[64:67], v[60:63], v[24:27]
  ds_read_b64_tr_b16 v[48:49], v16 offset:32768
  ds_read_b64_tr_b16 v[50:51], v16 offset:33280
  v_mfma_f32_16x16x32_bf16 v[28:31], v[68:71], v[56:59], v[28:31]
  ds_read_b64_tr_b16 v[52:53], v17 offset:32768
  ds_read_b64_tr_b16 v[54:55], v17 offset:33280
  v_mfma_f32_16x16x32_bf16 v[32:35], v[68:71], v[60:63], v[32:35]
  s_waitcnt lgkmcnt(0)
  v_mfma_f32_16x16x32_bf16 v[20:23], v[48:51], v[40:43], v[20:23]
  ds_read_b128 v[56:59], v12 offset:40960
  ds_read_b128 v[60:63], v12 offset:43008
  v_mfma_f32_16x16x32_bf16 v[24:27], v[48:51], v[44:47], v[24:27]
  ds_read_b64_tr_b16 v[64:65], v16 offset:40960
  ds_read_b64_tr_b16 v[66:67], v16 offset:41472
  v_mfma_f32_16x16x32_bf16 v[28:31], v[52:55], v[40:43], v[28:31]
  ds_read_b64_tr_b16 v[68:69], v17 offset:40960
  ds_read_b64_tr_b16 v[70:71], v17 offset:41472
  v_mfma_f32_16x16x32_bf16 v[32:35], v[52:55], v[44:47], v[32:35]
  s_waitcnt lgkmcnt(0)
  s_waitcnt vmcnt(1)
  s_barrier
  v_mfma_f32_16x16x32_bf16 v[20:23], v[64:67], v[56:59], v[20:23]
  ds_read_b128 v[40:43], v12 offset:49152
  ds_read_b128 v[44:47], v12 offset:51200
  v_mfma_f32_16x16x32_bf16 v[24:27], v[64:67], v[60:63], v[24:27]
  ds_read_b64_tr_b16 v[48:49], v16 offset:49152
  ds_read_b64_tr_b16 v[50:51], v16 offset:49664
  v_mfma_f32_16x16x32_bf16 v[28:31], v[68:71], v[56:59], v[28:31]
  ds_read_b64_tr_b16 v[52:53], v17 offset:49152
  ds_read_b64_tr_b16 v[54:55], v17 offset:49664
  v_mfma_f32_16x16x32_bf16 v[32:35], v[68:71], v[60:63], v[32:35]
  s_waitcnt lgkmcnt(0)
  v_mfma_f32_16x16x32_bf16 v[20:23], v[48:51], v[40:43], v[20:23]
  ds_read_b128 v[56:59], v12 offset:57344
  ds_read_b128 v[60:63], v12 offset:59392
  v_mfma_f32_16x16x32_bf16 v[24:27], v[48:51], v[44:47], v[24:27]
  ds_read_b64_tr_b16 v[64:65], v16 offset:57344
  ds_read_b64_tr_b16 v[66:67], v16 offset:57856
  v_mfma_f32_16x16x32_bf16 v[28:31], v[52:55], v[40:43], v[28:31]
  ds_read_b64_tr_b16 v[68:69], v17 offset:57344
  ds_read_b64_tr_b16 v[70:71], v17 offset:57856
  v_mfma_f32_16x16x32_bf16 v[32:35], v[52:55], v[44:47], v[32:35]
  s_waitcnt lgkmcnt(0)
  v_mfma_f32_16x16x32_bf16 v[20:23], v[64:67], v[56:59], v[20:23]
  v_mfma_f32_16x16x32_bf16 v[24:27], v[64:67], v[60:63], v[24:27]
  v_mfma_f32_16x16x32_bf16 v[28:31], v[68:71], v[56:59], v[28:31]
  v_mfma_f32_16x16x32_bf16 v[32:35], v[68:71], v[60:63], v[32:35]
  s_nop 4
  ds_write_b128 v72, v[20:23] offset:0
  ds_write_b128 v72, v[24:27] offset:4096
  ds_write_b128 v73, v[28:31] offset:0
  ds_write_b128 v73, v[32:35] offset:4096
  s_waitcnt vmcnt(0)
  v_lshlrev_b32 v56, 16, v36
  v_and_b32 v57, 0xffff0000, v36
  v_lshlrev_b32 v58, 16, v37
  v_and_b32 v59, 0xffff0000, v37
  v_lshlrev_b32 v60, 16, v38
  v_and_b32 v61, 0xffff0000, v38
  v_lshlrev_b32 v62, 16, v39
  v_and_b32 v63, 0xffff0000, v39
  s_waitcnt lgkmcnt(0)
  s_barrier
  ds_read_b128 v[40:43], v74
  ds_read_b128 v[44:47], v75
  ds_read_b128 v[48:51], v74 offset:16384
  ds_read_b128 v[52:55], v75 offset:16384
  s_waitcnt lgkmcnt(2)
  v_pk_add_f32 v[40:41], v[40:41], v[56:57]
  v_pk_add_f32 v[42:43], v[42:43], v[58:59]
  v_pk_add_f32 v[44:45], v[44:45], v[60:61]
  v_pk_add_f32 v[46:47], v[46:47], v[62:63]
  s_waitcnt lgkmcnt(0)
  v_pk_add_f32 v[40:41], v[40:41], v[48:49]
  v_pk_add_f32 v[42:43], v[42:43], v[50:51]
  v_pk_add_f32 v[44:45], v[44:45], v[52:53]
  v_pk_add_f32 v[46:47], v[46:47], v[54:55]
  v_cvt_pk_bf16_f32 v252, v40, v41
  v_cvt_pk_bf16_f32 v253, v42, v43
  v_cvt_pk_bf16_f32 v254, v44, v45
  v_cvt_pk_bf16_f32 v255, v46, v47
  buffer_store_dwordx4 v[252:255], v9, s[40:43], 0 offen sc1
  v_pk_mul_f32 v[48:49], v[40:41], v[40:41]
  v_pk_mul_f32 v[50:51], v[42:43], v[42:43]
  v_pk_mul_f32 v[52:53], v[44:45], v[44:45]
  v_pk_mul_f32 v[54:55], v[46:47], v[46:47]
  v_pk_add_f32 v[40:41], v[40:41], v[42:43]
  v_pk_add_f32 v[48:49], v[48:49], v[50:51]
  v_pk_add_f32 v[44:45], v[44:45], v[46:47]
  v_pk_add_f32 v[52:53], v[52:53], v[54:55]
  v_pk_add_f32 v[40:41], v[40:41], v[44:45]
  v_pk_add_f32 v[48:49], v[48:49], v[52:53]
  v_add_f32 v56, v40, v41
  v_add_f32 v57, v48, v49
  s_nop 0
  v_add_f32_dpp v56, v56, v56 quad_perm:[1,0,3,2] row_mask:0xf bank_mask:0xf
  v_add_f32_dpp v57, v57, v57 quad_perm:[1,0,3,2] row_mask:0xf bank_mask:0xf
  s_nop 0
  v_add_f32_dpp v56, v56, v56 quad_perm:[2,3,0,1] row_mask:0xf bank_mask:0xf
  v_add_f32_dpp v57, v57, v57 quad_perm:[2,3,0,1] row_mask:0xf bank_mask:0xf
  s_nop 0
  v_add_f32_dpp v56, v56, v56 row_half_mirror row_mask:0xf bank_mask:0xf
  v_add_f32_dpp v57, v57, v57 row_half_mirror row_mask:0xf bank_mask:0xf
  buffer_store_dwordx2 v[56:57], v76, s[36:39], s67 offen sc1
  s_mov_b32 s14, s58
  s_add_u32 s40, s26, 11534336
  s_addc_u32 s41, s27, 0
  s_mov_b32 s42, 7340032
  s_mov_b32 s43, 0x20000
  v_and_b32 v5, 15, v1
  s_lshl_b32 s54, s0, 4
  v_add_u32 v6, s54, v5
  v_lshlrev_b32 v6, 7, v6
  v_add_u32 v6, 98304, v6
  s_mul_i32 s54, s0, 458752
  s_mul_i32 s55, s1, 224
  s_add_u32 s68, s54, s55
  s_mov_b32 s56, 0x12492493
  s_mov_b32 s57, 3584
  v_add_u32 v32, 0, v0
  v_mul_hi_u32 v33, v32, s56
  v_mul_u32_u24 v34, 14, v33
  v_sub_u32 v34, v32, v34
  v_lshrrev_b32 v35, 5, v33
  v_and_b32 v33, 31, v33
  v_lshl_add_u32 v33, v35, 6, v33
  v_add_u32 v33, 32, v33
  v_mul_u32_u24 v244, 240, v33
  v_lshl_add_u32 v244, v34, 4, v244
  v_add_u32 v244, 131072, v244
  v_mul_lo_u32 v246, v33, s57
  v_lshl_add_u32 v246, v34, 4, v246
  v_add_u32 v32, 512, v0
  v_mul_hi_u32 v33, v32, s56
  v_mul_u32_u24 v34, 14, v33
  v_sub_u32 v34, v32, v34
  v_lshrrev_b32 v35, 5, v33
  v_and_b32 v33, 31, v33
  v_lshl_add_u32 v33, v35, 6, v33
  v_add_u32 v33, 32, v33
  v_mul_u32_u24 v245, 240, v33
  v_lshl_add_u32 v245, v34, 4, v245
  v_add_u32 v245, 131072, v245
  v_mul_lo_u32 v247, v33, s57
  v_lshl_add_u32 v247, v34, 4, v247
  v_mov_b32 v35, 0x7fffffff
  v_cmp_gt_u32 vcc, 896, v32
  s_nop 1
  v_cndmask_b32 v247, v35, v247, vcc
  v_mov_b32 v35, 131072
  v_cndmask_b32 v245, v35, v245, vcc
  s_cmp_ge_u32 s48, 4
  s_cbranch_scc1 Lprod_48
  s_lshr_b32 s52, s48, 1
  s_and_b32 s53, s48, 1
  s_lshl_b32 s57, s52, 13
  v_and_b32 v2, 15, v1
  v_lshrrev_b32 v3, 4, v1
  v_and_b32 v4, 7, v2
  v_xor_b32 v3, v3, v4
  v_lshlrev_b32 v3, 4, v3
  v_lshl_add_u32 v12, v2, 7, v3
  v_add_u32 v12, s57, v12
  v_xor_b32 v13, 64, v12
  v_add_u32 v14, 16384, v12
  v_add_u32 v15, 16384, v13
  v_add_u32 v16, 32768, v12
  v_add_u32 v17, 32768, v13
  v_lshrrev_b32 v2, 4, v1
  v_bfe_u32 v3, v1, 2, 2
  v_lshl_add_u32 v4, v2, 3, v3
  v_lshlrev_b32 v4, 8, v4
  v_and_b32 v2, 1, v2
  v_lshl_add_u32 v3, v2, 2, v3
  v_and_b32 v5, 3, v1
  s_lshl_b32 s54, s53, 2
  s_add_u32 s55, s54, 0
  v_xor_b32 v7, s55, v3
  v_lshl_add_u32 v7, v7, 5, v4
  v_lshl_add_u32 v18, v5, 3, v7
  s_add_u32 s55, s54, 1
  v_xor_b32 v7, s55, v3
  v_lshl_add_u32 v7, v7, 5, v4
  v_lshl_add_u32 v19, v5, 3, v7
  s_add_u32 s55, s54, 2
  v_xor_b32 v7, s55, v3
  v_lshl_add_u32 v7, v7, 5, v4
  v_lshl_add_u32 v20, v5, 3, v7
  v_xor_b32 v7, 3, v3
  v_lshl_add_u32 v7, v7, 5, v4
  v_and_b32 v8, 1, v5
  v_lshl_add_u32 v7, v8, 3, v7
  v_lshrrev_b32 v8, 1, v5
  v_lshl_add_u32 v7, v8, 14, v7
  s_lshl_b32 s55, s53, 4
  v_add_u32 v21, s55, v7
  v_add_u32 v22, 49152, v18
  v_add_u32 v23, 49152, v19
  v_add_u32 v24, 49152, v20
  v_add_u32 v25, 49152, v21
  v_add_u32 v26, 81920, v18
  v_add_u32 v27, 81920, v19
  v_add_u32 v28, 81920, v20
  v_add_u32 v29, 81920, v21
  v_add_u32 v18, 131072, v18
  v_add_u32 v19, 131072, v19
  v_add_u32 v20, 131072, v20
  v_add_u32 v21, 131072, v21
  v_mov_b64 v[32:33], 0
  v_mov_b64 v[34:35], 0
  v_mov_b64 v[36:37], 0
  v_mov_b64 v[38:39], 0
  v_mov_b64 v[40:41], 0
  v_mov_b64 v[42:43], 0
  v_mov_b64 v[44:45], 0
  v_mov_b64 v[46:47], 0
  v_mov_b64 v[48:49], 0
  v_mov_b64 v[50:51], 0
  v_mov_b64 v[52:53], 0
  v_mov_b64 v[54:55], 0
  v_mov_b64 v[56:57], 0
  v_mov_b64 v[58:59], 0
  v_mov_b64 v[60:61], 0
  v_mov_b64 v[62:63], 0
  v_mov_b64 v[64:65], 0
  v_mov_b64 v[66:67], 0
  v_mov_b64 v[68:69], 0
  v_mov_b64 v[70:71], 0
  v_mov_b64 v[72:73], 0
  v_mov_b64 v[74:75], 0
  v_mov_b64 v[76:77], 0
  v_mov_b64 v[78:79], 0
  v_mov_b64 v[80:81], 0
  v_mov_b64 v[82:83], 0
  v_mov_b64 v[84:85], 0
  v_mov_b64 v[86:87], 0
  v_mov_b64 v[88:89], 0
  v_mov_b64 v[90:91], 0
  v_mov_b64 v[92:93], 0
  v_mov_b64 v[94:95], 0
  v_mov_b64 v[96:97], 0
  v_mov_b64 v[98:99], 0
  v_mov_b64 v[100:101], 0
  v_mov_b64 v[102:103], 0
  v_mov_b64 v[104:105], 0
  v_mov_b64 v[106:107], 0
  v_mov_b64 v[108:109], 0
  v_mov_b64 v[110:111], 0
  v_mov_b64 v[112:113], 0
  v_mov_b64 v[114:115], 0
  v_mov_b64 v[116:117], 0
  v_mov_b64 v[118:119], 0
  v_mov_b64 v[120:121], 0
  v_mov_b64 v[122:123], 0
  v_mov_b64 v[124:125], 0
  v_mov_b64 v[126:127], 0
  v_mov_b64 v[128:129], 0
  v_mov_b64 v[130:131], 0
  v_mov_b64 v[132:133], 0
  v_mov_b64 v[134:135], 0
  v_mov_b64 v[136:137], 0
  v_mov_b64 v[138:139], 0
  v_mov_b64 v[140:141], 0
  v_mov_b64 v[142:143], 0
  v_and_b32 v2, 15, v1
  v_lshrrev_b32 v3, 4, v1
  s_lshl_b32 s54, s52, 10
  s_add_u32 s54, s54, 115712
  v_lshl_add_u32 v232, v2, 4, s54
  v_lshrrev_b32 v5, 5, v1
  v_lshl_add_u32 v233, v5, 8, v232
  s_lshl_b32 s54, s53, 8
  s_add_u32 s54, s54, 114688
  v_lshl_add_u32 v234, v3, 4, s54
  v_and_b32 v5, 1, v3
  s_lshl_b32 s54, s53, 5
  s_add_u32 s54, s54, 114688
  v_lshl_add_u32 v235, v5, 4, s54
  s_mul_i32 s54, s52, 15360
  s_add_u32 s54, s54, 131072
  v_mul_u32_u24 v7, 240, v2
  v_lshl_add_u32 v7, v3, 3, v7
  v_add_u32 v7, s54, v7
  s_lshl_b32 s55, s53, 7
  v_add_u32 v236, s55, v7
  v_lshrrev_b32 v8, 5, v1
  v_mul_u32_u24 v8, 3840, v8
  v_mul_u32_u24 v9, 240, v2
  v_add_u32 v8, v8, v9
  v_and_b32 v9, 1, v3
  v_lshl_add_u32 v8, v9, 3, v8
  s_lshl_b32 s55, s53, 4
  s_add_u32 s55, s55, s54
  s_add_u32 s55, s55, 96
  v_add_u32 v237, s55, v8
  s_waitcnt vmcnt(0)
  s_barrier
  s_cmp_eq_u32 s48, 0
  s_cbranch_scc0 Lsig_50
  s_lshl_b32 s54, s14, 7
  s_add_u32 s54, s54, 98304
  v_mov_b32 v2, s4
  v_mov_b32 v3, 0
  s_mov_b64 exec, 1
  buffer_store_dword v2, v3, s[44:47], s54 offen sc1
  s_mov_b64 exec, -1
Lsig_50:
  s_cmp_eq_u32 s48, 0
  s_cbranch_scc0 Lw_51
  s_mov_b32 s3, 0
Lp_52:
  buffer_load_dword v2, v6, s[44:47], 0 offen sc1
  s_waitcnt vmcnt(0)
  v_cmp_ne_u32 vcc, s4, v2
  s_nop 0
  s_and_b32 s71, vcc_lo, 771
  s_cbranch_scc0 Lo_53
  s_add_u32 s3, s3, 1
  s_cmp_lt_u32 s3, 400000
  s_cbranch_scc1 Lp_52
Lo_53:
Lw_51:
  s_barrier
  s_cmp_eq_u32 s48, 0
  s_cbranch_scc0 Lw_54
  s_mov_b32 s3, 0
Lp_55:
  buffer_load_dword v2, v6, s[44:47], 0 offen sc1
  s_waitcnt vmcnt(0)
  v_cmp_ne_u32 vcc, s4, v2
  s_cbranch_vccz Lo_56
  s_add_u32 s3, s3, 1
  s_cmp_lt_u32 s3, 400000
  s_cbranch_scc1 Lp_55
Lo_56:
Lw_54:
  s_barrier
  ds_read_b128 v[144:147], v12 offset:0
  ds_read_b64_tr_b16 v[160:161], v18 offset:0
  ds_read_b64_tr_b16 v[162:163], v18 offset:1024
  ds_read_b128 v[148:151], v12 offset:2048
  ds_read_b128 v[152:155], v12 offset:4096
  ds_read_b128 v[156:159], v12 offset:6144
  ds_read_b64_tr_b16 v[172:173], v18 offset:16384
  ds_read_b64_tr_b16 v[174:175], v18 offset:17408
  ds_read_b64_tr_b16 v[164:165], v19 offset:0
  ds_read_b64_tr_b16 v[166:167], v19 offset:1024
  ds_read_b64_tr_b16 v[176:177], v19 offset:16384
  ds_read_b64_tr_b16 v[178:179], v19 offset:17408
  ds_read_b64_tr_b16 v[168:169], v20 offset:0
  ds_read_b64_tr_b16 v[170:171], v20 offset:1024
  ds_read_b64_tr_b16 v[180:181], v20 offset:16384
  ds_read_b64_tr_b16 v[182:183], v20 offset:17408
  ds_read_b64_tr_b16 v[184:185], v21 offset:0
  ds_read_b64_tr_b16 v[186:187], v21 offset:1024
  s_waitcnt lgkmcnt(0)
  v_mfma_f32_16x16x32_bf16 v[32:35], v[160:163], v[144:147], v[32:35]
  ds_read_b128 v[188:191], v13 offset:0
  v_mfma_f32_16x16x32_bf16 v[36:39], v[160:163], v[148:151], v[36:39]
  ds_read_b64_tr_b16 v[204:205], v18 offset:8192
  v_mfma_f32_16x16x32_bf16 v[40:43], v[160:163], v[152:155], v[40:43]
  ds_read_b64_tr_b16 v[206:207], v18 offset:9216
  v_mfma_f32_16x16x32_bf16 v[44:47], v[160:163], v[156:159], v[44:47]
  ds_read_b128 v[192:195], v13 offset:2048
  v_mfma_f32_16x16x32_bf16 v[80:83], v[172:175], v[144:147], v[80:83]
  ds_read_b128 v[196:199], v13 offset:4096
  v_mfma_f32_16x16x32_bf16 v[84:87], v[172:175], v[148:151], v[84:87]
  ds_read_b128 v[200:203], v13 offset:6144
  v_mfma_f32_16x16x32_bf16 v[88:91], v[172:175], v[152:155], v[88:91]
  ds_read_b64_tr_b16 v[216:217], v18 offset:24576
  v_mfma_f32_16x16x32_bf16 v[92:95], v[172:175], v[156:159], v[92:95]
  ds_read_b64_tr_b16 v[218:219], v18 offset:25600
  v_mfma_f32_16x16x32_bf16 v[48:51], v[164:167], v[144:147], v[48:51]
  ds_read_b64_tr_b16 v[208:209], v19 offset:8192
  v_mfma_f32_16x16x32_bf16 v[52:55], v[164:167], v[148:151], v[52:55]
  ds_read_b64_tr_b16 v[210:211], v19 offset:9216
  v_mfma_f32_16x16x32_bf16 v[56:59], v[164:167], v[152:155], v[56:59]
  ds_read_b64_tr_b16 v[220:221], v19 offset:24576
  v_mfma_f32_16x16x32_bf16 v[60:63], v[164:167], v[156:159], v[60:63]
  ds_read_b64_tr_b16 v[222:223], v19 offset:25600
  v_mfma_f32_16x16x32_bf16 v[96:99], v[176:179], v[144:147], v[96:99]
  ds_read_b64_tr_b16 v[212:213], v20 offset:8192
  v_mfma_f32_16x16x32_bf16 v[100:103], v[176:179], v[148:151], v[100:103]
  ds_read_b64_tr_b16 v[214:215], v20 offset:9216
  v_mfma_f32_16x16x32_bf16 v[104:107], v[176:179], v[152:155], v[104:107]
  ds_read_b64_tr_b16 v[224:225], v20 offset:24576
  v_mfma_f32_16x16x32_bf16 v[108:111], v[176:179], v[156:159], v[108:111]
  ds_read_b64_tr_b16 v[226:227], v20 offset:25600
  v_mfma_f32_16x16x32_bf16 v[64:67], v[168:171], v[144:147], v[64:67]
  ds_read_b64_tr_b16 v[228:229], v21 offset:8192
  v_mfma_f32_16x16x32_bf16 v[68:71], v[168:171], v[148:151], v[68:71]
  ds_read_b64_tr_b16 v[230:231], v21 offset:9216
  v_mfma_f32_16x16x32_bf16 v[72:75], v[168:171], v[152:155], v[72:75]
  v_mfma_f32_16x16x32_bf16 v[76:79], v[168:171], v[156:159], v[76:79]
  v_mfma_f32_16x16x32_bf16 v[112:115], v[180:183], v[144:147], v[112:115]
  v_mfma_f32_16x16x32_bf16 v[116:119], v[180:183], v[148:151], v[116:119]
  v_mfma_f32_16x16x32_bf16 v[120:123], v[180:183], v[152:155], v[120:123]
  v_mfma_f32_16x16x32_bf16 v[124:127], v[180:183], v[156:159], v[124:127]
  v_mfma_f32_16x16x32_bf16 v[128:131], v[184:187], v[144:147], v[128:131]
  v_mfma_f32_16x16x32_bf16 v[132:135], v[184:187], v[148:151], v[132:135]
  v_mfma_f32_16x16x32_bf16 v[136:139], v[184:187], v[152:155], v[136:139]
  v_mfma_f32_16x16x32_bf16 v[140:143], v[184:187], v[156:159], v[140:143]
  s_waitcnt lgkmcnt(0)
  s_barrier
  v_mfma_f32_16x16x32_bf16 v[32:35], v[204:207], v[188:191], v[32:35]
  ds_read_b128 v[144:147], v14 offset:0
  v_mfma_f32_16x16x32_bf16 v[36:39], v[204:207], v[192:195], v[36:39]
  ds_read_b64_tr_b16 v[160:161], v22 offset:0
  v_mfma_f32_16x16x32_bf16 v[40:43], v[204:207], v[196:199], v[40:43]
  ds_read_b64_tr_b16 v[162:163], v22 offset:1024
  v_mfma_f32_16x16x32_bf16 v[44:47], v[204:207], v[200:203], v[44:47]
  ds_read_b128 v[148:151], v14 offset:2048
  v_mfma_f32_16x16x32_bf16 v[80:83], v[216:219], v[188:191], v[80:83]
  ds_read_b128 v[152:155], v14 offset:4096
  v_mfma_f32_16x16x32_bf16 v[84:87], v[216:219], v[192:195], v[84:87]
  ds_read_b128 v[156:159], v14 offset:6144
  v_mfma_f32_16x16x32_bf16 v[88:91], v[216:219], v[196:199], v[88:91]
  ds_read_b64_tr_b16 v[172:173], v22 offset:16384
  v_mfma_f32_16x16x32_bf16 v[92:95], v[216:219], v[200:203], v[92:95]
  ds_read_b64_tr_b16 v[174:175], v22 offset:17408
  v_mfma_f32_16x16x32_bf16 v[48:51], v[208:211], v[188:191], v[48:51]
  ds_read_b64_tr_b16 v[164:165], v23 offset:0
  v_mfma_f32_16x16x32_bf16 v[52:55], v[208:211], v[192:195], v[52:55]
  ds_read_b64_tr_b16 v[166:167], v23 offset:1024
  v_mfma_f32_16x16x32_bf16 v[56:59], v[208:211], v[196:199], v[56:59]
  ds_read_b64_tr_b16 v[176:177], v23 offset:16384
  v_mfma_f32_16x16x32_bf16 v[60:63], v[208:211], v[200:203], v[60:63]
  ds_read_b64_tr_b16 v[178:179], v23 offset:17408
  v_mfma_f32_16x16x32_bf16 v[96:99], v[220:223], v[188:191], v[96:99]
  ds_read_b64_tr_b16 v[168:169], v24 offset:0
  v_mfma_f32_16x16x32_bf16 v[100:103], v[220:223], v[192:195], v[100:103]
  ds_read_b64_tr_b16 v[170:171], v24 offset:1024
  v_mfma_f32_16x16x32_bf16 v[104:107], v[220:223], v[196:199], v[104:107]
  ds_read_b64_tr_b16 v[180:181], v24 offset:16384
  v_mfma_f32_16x16x32_bf16 v[108:111], v[220:223], v[200:203], v[108:111]
  ds_read_b64_tr_b16 v[182:183], v24 offset:17408
  v_mfma_f32_16x16x32_bf16 v[64:67], v[212:215], v[188:191], v[64:67]
  ds_read_b64_tr_b16 v[184:185], v25 offset:0
  v_mfma_f32_16x16x32_bf16 v[68:71], v[212:215], v[192:195], v[68:71]
  ds_read_b64_tr_b16 v[186:187], v25 offset:1024
  v_mfma_f32_16x16x32_bf16 v[72:75], v[212:215], v[196:199], v[72:75]
  v_mfma_f32_16x16x32_bf16 v[76:79], v[212:215], v[200:203], v[76:79]
  v_mfma_f32_16x16x32_bf16 v[112:115], v[224:227], v[188:191], v[112:115]
  v_mfma_f32_16x16x32_bf16 v[116:119], v[224:227], v[192:195], v[116:119]
  v_mfma_f32_16x16x32_bf16 v[120:123], v[224:227], v[196:199], v[120:123]
  v_mfma_f32_16x16x32_bf16 v[124:127], v[224:227], v[200:203], v[124:127]
  v_mfma_f32_16x16x32_bf16 v[128:131], v[228:231], v[188:191], v[128:131]
  v_mfma_f32_16x16x32_bf16 v[132:135], v[228:231], v[192:195], v[132:135]
  v_mfma_f32_16x16x32_bf16 v[136:139], v[228:231], v[196:199], v[136:139]
  v_mfma_f32_16x16x32_bf16 v[140:143], v[228:231], v[200:203], v[140:143]
  s_waitcnt lgkmcnt(0)
  v_mfma_f32_16x16x32_bf16 v[32:35], v[160:163], v[144:147], v[32:35]
  ds_read_b128 v[188:191], v15 offset:0
  v_mfma_f32_16x16x32_bf16 v[36:39], v[160:163], v[148:151], v[36:39]
  ds_read_b64_tr_b16 v[204:205], v22 offset:8192
  v_mfma_f32_16x16x32_bf16 v[40:43], v[160:163], v[152:155], v[40:43]
  ds_read_b64_tr_b16 v[206:207], v22 offset:9216
  v_mfma_f32_16x16x32_bf16 v[44:47], v[160:163], v[156:159], v[44:47]
  ds_read_b128 v[192:195], v15 offset:2048
  v_mfma_f32_16x16x32_bf16 v[80:83], v[172:175], v[144:147], v[80:83]
  ds_read_b128 v[196:199], v15 offset:4096
  v_mfma_f32_16x16x32_bf16 v[84:87], v[172:175], v[148:151], v[84:87]
  ds_read_b128 v[200:203], v15 offset:6144
  v_mfma_f32_16x16x32_bf16 v[88:91], v[172:175], v[152:155], v[88:91]
  ds_read_b64_tr_b16 v[216:217], v22 offset:24576
  v_mfma_f32_16x16x32_bf16 v[92:95], v[172:175], v[156:159], v[92:95]
  ds_read_b64_tr_b16 v[218:219], v22 offset:25600
  v_mfma_f32_16x16x32_bf16 v[48:51], v[164:167], v[144:147], v[48:51]
  ds_read_b64_tr_b16 v[208:209], v23 offset:8192
  v_mfma_f32_16x16x32_bf16 v[52:55], v[164:167], v[148:151], v[52:55]
  ds_read_b64_tr_b16 v[210:211], v23 offset:9216
  v_mfma_f32_16x16x32_bf16 v[56:59], v[164:167], v[152:155], v[56:59]
  ds_read_b64_tr_b16 v[220:221], v23 offset:24576
  v_mfma_f32_16x16x32_bf16 v[60:63], v[164:167], v[156:159], v[60:63]
  ds_read_b64_tr_b16 v[222:223], v23 offset:25600
  v_mfma_f32_16x16x32_bf16 v[96:99], v[176:179], v[144:147], v[96:99]
  ds_read_b64_tr_b16 v[212:213], v24 offset:8192
  v_mfma_f32_16x16x32_bf16 v[100:103], v[176:179], v[148:151], v[100:103]
  ds_read_b64_tr_b16 v[214:215], v24 offset:9216
  v_mfma_f32_16x16x32_bf16 v[104:107], v[176:179], v[152:155], v[104:107]
  ds_read_b64_tr_b16 v[224:225], v24 offset:24576
  v_mfma_f32_16x16x32_bf16 v[108:111], v[176:179], v[156:159], v[108:111]
  ds_read_b64_tr_b16 v[226:227], v24 offset:25600
  v_mfma_f32_16x16x32_bf16 v[64:67], v[168:171], v[144:147], v[64:67]
  ds_read_b64_tr_b16 v[228:229], v25 offset:8192
  v_mfma_f32_16x16x32_bf16 v[68:71], v[168:171], v[148:151], v[68:71]
  ds_read_b64_tr_b16 v[230:231], v25 offset:9216
  v_mfma_f32_16x16x32_bf16 v[72:75], v[168:171], v[152:155], v[72:75]
  v_mfma_f32_16x16x32_bf16 v[76:79], v[168:171], v[156:159], v[76:79]
  v_mfma_f32_16x16x32_bf16 v[112:115], v[180:183], v[144:147], v[112:115]
  v_mfma_f32_16x16x32_bf16 v[116:119], v[180:183], v[148:151], v[116:119]
  v_mfma_f32_16x16x32_bf16 v[120:123], v[180:183], v[152:155], v[120:123]
  v_mfma_f32_16x16x32_bf16 v[124:127], v[180:183], v[156:159], v[124:127]
  v_mfma_f32_16x16x32_bf16 v[128:131], v[184:187], v[144:147], v[128:131]
  v_mfma_f32_16x16x32_bf16 v[132:135], v[184:187], v[148:151], v[132:135]
  v_mfma_f32_16x16x32_bf16 v[136:139], v[184:187], v[152:155], v[136:139]
  v_mfma_f32_16x16x32_bf16 v[140:143], v[184:187], v[156:159], v[140:143]
  s_waitcnt lgkmcnt(0)
  s_barrier
  v_mfma_f32_16x16x32_bf16 v[32:35], v[204:207], v[188:191], v[32:35]
  ds_read_b128 v[144:147], v16 offset:0
  v_mfma_f32_16x16x32_bf16 v[36:39], v[204:207], v[192:195], v[36:39]
  ds_read_b64_tr_b16 v[160:161], v26 offset:0
  v_mfma_f32_16x16x32_bf16 v[40:43], v[204:207], v[196:199], v[40:43]
  ds_read_b64_tr_b16 v[162:163], v26 offset:1024
  v_mfma_f32_16x16x32_bf16 v[44:47], v[204:207], v[200:203], v[44:47]
  ds_read_b128 v[148:151], v16 offset:2048
  v_mfma_f32_16x16x32_bf16 v[80:83], v[216:219], v[188:191], v[80:83]
  ds_read_b128 v[152:155], v16 offset:4096
  v_mfma_f32_16x16x32_bf16 v[84:87], v[216:219], v[192:195], v[84:87]
  ds_read_b128 v[156:159], v16 offset:6144
  v_mfma_f32_16x16x32_bf16 v[88:91], v[216:219], v[196:199], v[88:91]
  ds_read_b64_tr_b16 v[172:173], v26 offset:16384
  v_mfma_f32_16x16x32_bf16 v[92:95], v[216:219], v[200:203], v[92:95]
  ds_read_b64_tr_b16 v[174:175], v26 offset:17408
  v_mfma_f32_16x16x32_bf16 v[48:51], v[208:211], v[188:191], v[48:51]
  ds_read_b64_tr_b16 v[164:165], v27 offset:0
  v_mfma_f32_16x16x32_bf16 v[52:55], v[208:211], v[192:195], v[52:55]
  ds_read_b64_tr_b16 v[166:167], v27 offset:1024
  v_mfma_f32_16x16x32_bf16 v[56:59], v[208:211], v[196:199], v[56:59]
  ds_read_b64_tr_b16 v[176:177], v27 offset:16384
  v_mfma_f32_16x16x32_bf16 v[60:63], v[208:211], v[200:203], v[60:63]
  ds_read_b64_tr_b16 v[178:179], v27 offset:17408
  v_mfma_f32_16x16x32_bf16 v[96:99], v[220:223], v[188:191], v[96:99]
  ds_read_b64_tr_b16 v[168:169], v28 offset:0
  v_mfma_f32_16x16x32_bf16 v[100:103], v[220:223], v[192:195], v[100:103]
  ds_read_b64_tr_b16 v[170:171], v28 offset:1024
  v_mfma_f32_16x16x32_bf16 v[104:107], v[220:223], v[196:199], v[104:107]
  ds_read_b64_tr_b16 v[180:181], v28 offset:16384
  v_mfma_f32_16x16x32_bf16 v[108:111], v[220:223], v[200:203], v[108:111]
  ds_read_b64_tr_b16 v[182:183], v28 offset:17408
  v_mfma_f32_16x16x32_bf16 v[64:67], v[212:215], v[188:191], v[64:67]
  ds_read_b64_tr_b16 v[184:185], v29 offset:0
  v_mfma_f32_16x16x32_bf16 v[68:71], v[212:215], v[192:195], v[68:71]
  ds_read_b64_tr_b16 v[186:187], v29 offset:1024
  v_mfma_f32_16x16x32_bf16 v[72:75], v[212:215], v[196:199], v[72:75]
  v_mfma_f32_16x16x32_bf16 v[76:79], v[212:215], v[200:203], v[76:79]
  v_mfma_f32_16x16x32_bf16 v[112:115], v[224:227], v[188:191], v[112:115]
  v_mfma_f32_16x16x32_bf16 v[116:119], v[224:227], v[192:195], v[116:119]
  v_mfma_f32_16x16x32_bf16 v[120:123], v[224:227], v[196:199], v[120:123]
  v_mfma_f32_16x16x32_bf16 v[124:127], v[224:227], v[200:203], v[124:127]
  v_mfma_f32_16x16x32_bf16 v[128:131], v[228:231], v[188:191], v[128:131]
  v_mfma_f32_16x16x32_bf16 v[132:135], v[228:231], v[192:195], v[132:135]
  v_mfma_f32_16x16x32_bf16 v[136:139], v[228:231], v[196:199], v[136:139]
  v_mfma_f32_16x16x32_bf16 v[140:143], v[228:231], v[200:203], v[140:143]
  s_waitcnt lgkmcnt(0)
  v_mfma_f32_16x16x32_bf16 v[32:35], v[160:163], v[144:147], v[32:35]
  ds_read_b128 v[188:191], v17 offset:0
  v_mfma_f32_16x16x32_bf16 v[36:39], v[160:163], v[148:151], v[36:39]
  ds_read_b64_tr_b16 v[204:205], v26 offset:8192
  v_mfma_f32_16x16x32_bf16 v[40:43], v[160:163], v[152:155], v[40:43]
  ds_read_b64_tr_b16 v[206:207], v26 offset:9216
  v_mfma_f32_16x16x32_bf16 v[44:47], v[160:163], v[156:159], v[44:47]
  ds_read_b128 v[192:195], v17 offset:2048
  v_mfma_f32_16x16x32_bf16 v[80:83], v[172:175], v[144:147], v[80:83]
  ds_read_b128 v[196:199], v17 offset:4096
  v_mfma_f32_16x16x32_bf16 v[84:87], v[172:175], v[148:151], v[84:87]
  ds_read_b128 v[200:203], v17 offset:6144
  v_mfma_f32_16x16x32_bf16 v[88:91], v[172:175], v[152:155], v[88:91]
  ds_read_b64_tr_b16 v[216:217], v26 offset:24576
  v_mfma_f32_16x16x32_bf16 v[92:95], v[172:175], v[156:159], v[92:95]
  ds_read_b64_tr_b16 v[218:219], v26 offset:25600
  v_mfma_f32_16x16x32_bf16 v[48:51], v[164:167], v[144:147], v[48:51]
  ds_read_b64_tr_b16 v[208:209], v27 offset:8192
  v_mfma_f32_16x16x32_bf16 v[52:55], v[164:167], v[148:151], v[52:55]
  ds_read_b64_tr_b16 v[210:211], v27 offset:9216
  v_mfma_f32_16x16x32_bf16 v[56:59], v[164:167], v[152:155], v[56:59]
  ds_read_b64_tr_b16 v[220:221], v27 offset:24576
  v_mfma_f32_16x16x32_bf16 v[60:63], v[164:167], v[156:159], v[60:63]
  ds_read_b64_tr_b16 v[222:223], v27 offset:25600
  v_mfma_f32_16x16x32_bf16 v[96:99], v[176:179], v[144:147], v[96:99]
  ds_read_b64_tr_b16 v[212:213], v28 offset:8192
  v_mfma_f32_16x16x32_bf16 v[100:103], v[176:179], v[148:151], v[100:103]
  ds_read_b64_tr_b16 v[214:215], v28 offset:9216
  v_mfma_f32_16x16x32_bf16 v[104:107], v[176:179], v[152:155], v[104:107]
  ds_read_b64_tr_b16 v[224:225], v28 offset:24576
  v_mfma_f32_16x16x32_bf16 v[108:111], v[176:179], v[156:159], v[108:111]
  ds_read_b64_tr_b16 v[226:227], v28 offset:25600
  v_mfma_f32_16x16x32_bf16 v[64:67], v[168:171], v[144:147], v[64:67]
  ds_read_b64_tr_b16 v[228:229], v29 offset:8192
  v_mfma_f32_16x16x32_bf16 v[68:71], v[168:171], v[148:151], v[68:71]
  ds_read_b64_tr_b16 v[230:231], v29 offset:9216
  v_mfma_f32_16x16x32_bf16 v[72:75], v[168:171], v[152:155], v[72:75]
  v_mfma_f32_16x16x32_bf16 v[76:79], v[168:171], v[156:159], v[76:79]
  v_mfma_f32_16x16x32_bf16 v[112:115], v[180:183], v[144:147], v[112:115]
  v_mfma_f32_16x16x32_bf16 v[116:119], v[180:183], v[148:151], v[116:119]
  v_mfma_f32_16x16x32_bf16 v[120:123], v[180:183], v[152:155], v[120:123]
  v_mfma_f32_16x16x32_bf16 v[124:127], v[180:183], v[156:159], v[124:127]
  v_mfma_f32_16x16x32_bf16 v[128:131], v[184:187], v[144:147], v[128:131]
  v_mfma_f32_16x16x32_bf16 v[132:135], v[184:187], v[148:151], v[132:135]
  v_mfma_f32_16x16x32_bf16 v[136:139], v[184:187], v[152:155], v[136:139]
  v_mfma_f32_16x16x32_bf16 v[140:143], v[184:187], v[156:159], v[140:143]
  s_waitcnt lgkmcnt(0)
  s_barrier
  v_mfma_f32_16x16x32_bf16 v[32:35], v[204:207], v[188:191], v[32:35]
  ds_read_b128 v[144:147], v12 offset:0
  v_mfma_f32_16x16x32_bf16 v[36:39], v[204:207], v[192:195], v[36:39]
  ds_read_b64_tr_b16 v[160:161], v18 offset:0
  v_mfma_f32_16x16x32_bf16 v[40:43], v[204:207], v[196:199], v[40:43]
  ds_read_b64_tr_b16 v[162:163], v18 offset:1024
  v_mfma_f32_16x16x32_bf16 v[44:47], v[204:207], v[200:203], v[44:47]
  ds_read_b128 v[148:151], v12 offset:2048
  v_mfma_f32_16x16x32_bf16 v[80:83], v[216:219], v[188:191], v[80:83]
  ds_read_b128 v[152:155], v12 offset:4096
  v_mfma_f32_16x16x32_bf16 v[84:87], v[216:219], v[192:195], v[84:87]
  ds_read_b128 v[156:159], v12 offset:6144
  v_mfma_f32_16x16x32_bf16 v[88:91], v[216:219], v[196:199], v[88:91]
  ds_read_b64_tr_b16 v[172:173], v18 offset:16384
  v_mfma_f32_16x16x32_bf16 v[92:95], v[216:219], v[200:203], v[92:95]
  ds_read_b64_tr_b16 v[174:175], v18 offset:17408
  v_mfma_f32_16x16x32_bf16 v[48:51], v[208:211], v[188:191], v[48:51]
  ds_read_b64_tr_b16 v[164:165], v19 offset:0
  v_mfma_f32_16x16x32_bf16 v[52:55], v[208:211], v[192:195], v[52:55]
  ds_read_b64_tr_b16 v[166:167], v19 offset:1024
  v_mfma_f32_16x16x32_bf16 v[56:59], v[208:211], v[196:199], v[56:59]
  ds_read_b64_tr_b16 v[176:177], v19 offset:16384
  v_mfma_f32_16x16x32_bf16 v[60:63], v[208:211], v[200:203], v[60:63]
  ds_read_b64_tr_b16 v[178:179], v19 offset:17408
  v_mfma_f32_16x16x32_bf16 v[96:99], v[220:223], v[188:191], v[96:99]
  ds_read_b64_tr_b16 v[168:169], v20 offset:0
  v_mfma_f32_16x16x32_bf16 v[100:103], v[220:223], v[192:195], v[100:103]
  ds_read_b64_tr_b16 v[170:171], v20 offset:1024
  v_mfma_f32_16x16x32_bf16 v[104:107], v[220:223], v[196:199], v[104:107]
  ds_read_b64_tr_b16 v[180:181], v20 offset:16384
  v_mfma_f32_16x16x32_bf16 v[108:111], v[220:223], v[200:203], v[108:111]
  ds_read_b64_tr_b16 v[182:183], v20 offset:17408
  v_mfma_f32_16x16x32_bf16 v[64:67], v[212:215], v[188:191], v[64:67]
  ds_read_b64_tr_b16 v[184:185], v21 offset:0
  v_mfma_f32_16x16x32_bf16 v[68:71], v[212:215], v[192:195], v[68:71]
  ds_read_b64_tr_b16 v[186:187], v21 offset:1024
  v_mfma_f32_16x16x32_bf16 v[72:75], v[212:215], v[196:199], v[72:75]
  v_mfma_f32_16x16x32_bf16 v[76:79], v[212:215], v[200:203], v[76:79]
  v_mfma_f32_16x16x32_bf16 v[112:115], v[224:227], v[188:191], v[112:115]
  v_mfma_f32_16x16x32_bf16 v[116:119], v[224:227], v[192:195], v[116:119]
  v_mfma_f32_16x16x32_bf16 v[120:123], v[224:227], v[196:199], v[120:123]
  v_mfma_f32_16x16x32_bf16 v[124:127], v[224:227], v[200:203], v[124:127]
  v_mfma_f32_16x16x32_bf16 v[128:131], v[228:231], v[188:191], v[128:131]
  v_mfma_f32_16x16x32_bf16 v[132:135], v[228:231], v[192:195], v[132:135]
  v_mfma_f32_16x16x32_bf16 v[136:139], v[228:231], v[196:199], v[136:139]
  v_mfma_f32_16x16x32_bf16 v[140:143], v[228:231], v[200:203], v[140:143]
  s_waitcnt lgkmcnt(0)
  v_mfma_f32_16x16x32_bf16 v[32:35], v[160:163], v[144:147], v[32:35]
  ds_read_b128 v[188:191], v13 offset:0
  v_mfma_f32_16x16x32_bf16 v[36:39], v[160:163], v[148:151], v[36:39]
  ds_read_b64_tr_b16 v[204:205], v18 offset:8192
  v_mfma_f32_16x16x32_bf16 v[40:43], v[160:163], v[152:155], v[40:43]
  ds_read_b64_tr_b16 v[206:207], v18 offset:9216
  v_mfma_f32_16x16x32_bf16 v[44:47], v[160:163], v[156:159], v[44:47]
  ds_read_b128 v[192:195], v13 offset:2048
  v_mfma_f32_16x16x32_bf16 v[80:83], v[172:175], v[144:147], v[80:83]
  ds_read_b128 v[196:199], v13 offset:4096
  v_mfma_f32_16x16x32_bf16 v[84:87], v[172:175], v[148:151], v[84:87]
  ds_read_b128 v[200:203], v13 offset:6144
  v_mfma_f32_16x16x32_bf16 v[88:91], v[172:175], v[152:155], v[88:91]
  ds_read_b64_tr_b16 v[216:217], v18 offset:24576
  v_mfma_f32_16x16x32_bf16 v[92:95], v[172:175], v[156:159], v[92:95]
  ds_read_b64_tr_b16 v[218:219], v18 offset:25600
  v_mfma_f32_16x16x32_bf16 v[48:51], v[164:167], v[144:147], v[48:51]
  ds_read_b64_tr_b16 v[208:209], v19 offset:8192
  v_mfma_f32_16x16x32_bf16 v[52:55], v[164:167], v[148:151], v[52:55]
  ds_read_b64_tr_b16 v[210:211], v19 offset:9216
  v_mfma_f32_16x16x32_bf16 v[56:59], v[164:167], v[152:155], v[56:59]
  ds_read_b64_tr_b16 v[220:221], v19 offset:24576
  v_mfma_f32_16x16x32_bf16 v[60:63], v[164:167], v[156:159], v[60:63]
  ds_read_b64_tr_b16 v[222:223], v19 offset:25600
  v_mfma_f32_16x16x32_bf16 v[96:99], v[176:179], v[144:147], v[96:99]
  ds_read_b64_tr_b16 v[212:213], v20 offset:8192
  v_mfma_f32_16x16x32_bf16 v[100:103], v[176:179], v[148:151], v[100:103]
  ds_read_b64_tr_b16 v[214:215], v20 offset:9216
  v_mfma_f32_16x16x32_bf16 v[104:107], v[176:179], v[152:155], v[104:107]
  ds_read_b64_tr_b16 v[224:225], v20 offset:24576
  v_mfma_f32_16x16x32_bf16 v[108:111], v[176:179], v[156:159], v[108:111]
  ds_read_b64_tr_b16 v[226:227], v20 offset:25600
  v_mfma_f32_16x16x32_bf16 v[64:67], v[168:171], v[144:147], v[64:67]
  ds_read_b64_tr_b16 v[228:229], v21 offset:8192
  v_mfma_f32_16x16x32_bf16 v[68:71], v[168:171], v[148:151], v[68:71]
  ds_read_b64_tr_b16 v[230:231], v21 offset:9216
  v_mfma_f32_16x16x32_bf16 v[72:75], v[168:171], v[152:155], v[72:75]
  v_mfma_f32_16x16x32_bf16 v[76:79], v[168:171], v[156:159], v[76:79]
  v_mfma_f32_16x16x32_bf16 v[112:115], v[180:183], v[144:147], v[112:115]
  v_mfma_f32_16x16x32_bf16 v[116:119], v[180:183], v[148:151], v[116:119]
  v_mfma_f32_16x16x32_bf16 v[120:123], v[180:183], v[152:155], v[120:123]
  v_mfma_f32_16x16x32_bf16 v[124:127], v[180:183], v[156:159], v[124:127]
  v_mfma_f32_16x16x32_bf16 v[128:131], v[184:187], v[144:147], v[128:131]
  v_mfma_f32_16x16x32_bf16 v[132:135], v[184:187], v[148:151], v[132:135]
  v_mfma_f32_16x16x32_bf16 v[136:139], v[184:187], v[152:155], v[136:139]
  v_mfma_f32_16x16x32_bf16 v[140:143], v[184:187], v[156:159], v[140:143]
  s_waitcnt lgkmcnt(0)
  s_barrier
  v_mfma_f32_16x16x32_bf16 v[32:35], v[204:207], v[188:191], v[32:35]
  ds_read_b128 v[144:147], v14 offset:0
  v_mfma_f32_16x16x32_bf16 v[36:39], v[204:207], v[192:195], v[36:39]
  ds_read_b64_tr_b16 v[160:161], v22 offset:0
  v_mfma_f32_16x16x32_bf16 v[40:43], v[204:207], v[196:199], v[40:43]
  ds_read_b64_tr_b16 v[162:163], v22 offset:1024
  v_mfma_f32_16x16x32_bf16 v[44:47], v[204:207], v[200:203], v[44:47]
  ds_read_b128 v[148:151], v14 offset:2048
  v_mfma_f32_16x16x32_bf16 v[80:83], v[216:219], v[188:191], v[80:83]
  ds_read_b128 v[152:155], v14 offset:4096
  v_mfma_f32_16x16x32_bf16 v[84:87], v[216:219], v[192:195], v[84:87]
  ds_read_b128 v[156:159], v14 offset:6144
  v_mfma_f32_16x16x32_bf16 v[88:91], v[216:219], v[196:199], v[88:91]
  ds_read_b64_tr_b16 v[172:173], v22 offset:16384
  v_mfma_f32_16x16x32_bf16 v[92:95], v[216:219], v[200:203], v[92:95]
  ds_read_b64_tr_b16 v[174:175], v22 offset:17408
  v_mfma_f32_16x16x32_bf16 v[48:51], v[208:211], v[188:191], v[48:51]
  ds_read_b64_tr_b16 v[164:165], v23 offset:0
  v_mfma_f32_16x16x32_bf16 v[52:55], v[208:211], v[192:195], v[52:55]
  ds_read_b64_tr_b16 v[166:167], v23 offset:1024
  v_mfma_f32_16x16x32_bf16 v[56:59], v[208:211], v[196:199], v[56:59]
  ds_read_b64_tr_b16 v[176:177], v23 offset:16384
  v_mfma_f32_16x16x32_bf16 v[60:63], v[208:211], v[200:203], v[60:63]
  ds_read_b64_tr_b16 v[178:179], v23 offset:17408
  v_mfma_f32_16x16x32_bf16 v[96:99], v[220:223], v[188:191], v[96:99]
  ds_read_b64_tr_b16 v[168:169], v24 offset:0
  v_mfma_f32_16x16x32_bf16 v[100:103], v[220:223], v[192:195], v[100:103]
  ds_read_b64_tr_b16 v[170:171], v24 offset:1024
  v_mfma_f32_16x16x32_bf16 v[104:107], v[220:223], v[196:199], v[104:107]
  ds_read_b64_tr_b16 v[180:181], v24 offset:16384
  v_mfma_f32_16x16x32_bf16 v[108:111], v[220:223], v[200:203], v[108:111]
  ds_read_b64_tr_b16 v[182:183], v24 offset:17408
  v_mfma_f32_16x16x32_bf16 v[64:67], v[212:215], v[188:191], v[64:67]
  ds_read_b64_tr_b16 v[184:185], v25 offset:0
  v_mfma_f32_16x16x32_bf16 v[68:71], v[212:215], v[192:195], v[68:71]
  ds_read_b64_tr_b16 v[186:187], v25 offset:1024
  v_mfma_f32_16x16x32_bf16 v[72:75], v[212:215], v[196:199], v[72:75]
  v_mfma_f32_16x16x32_bf16 v[76:79], v[212:215], v[200:203], v[76:79]
  v_mfma_f32_16x16x32_bf16 v[112:115], v[224:227], v[188:191], v[112:115]
  v_mfma_f32_16x16x32_bf16 v[116:119], v[224:227], v[192:195], v[116:119]
  v_mfma_f32_16x16x32_bf16 v[120:123], v[224:227], v[196:199], v[120:123]
  v_mfma_f32_16x16x32_bf16 v[124:127], v[224:227], v[200:203], v[124:127]
  v_mfma_f32_16x16x32_bf16 v[128:131], v[228:231], v[188:191], v[128:131]
  v_mfma_f32_16x16x32_bf16 v[132:135], v[228:231], v[192:195], v[132:135]
  v_mfma_f32_16x16x32_bf16 v[136:139], v[228:231], v[196:199], v[136:139]
  v_mfma_f32_16x16x32_bf16 v[140:143], v[228:231], v[200:203], v[140:143]
  s_waitcnt lgkmcnt(0)
  v_mfma_f32_16x16x32_bf16 v[32:35], v[160:163], v[144:147], v[32:35]
  ds_read_b128 v[188:191], v15 offset:0
  v_mfma_f32_16x16x32_bf16 v[36:39], v[160:163], v[148:151], v[36:39]
  ds_read_b64_tr_b16 v[204:205], v22 offset:8192
  v_mfma_f32_16x16x32_bf16 v[40:43], v[160:163], v[152:155], v[40:43]
  ds_read_b64_tr_b16 v[206:207], v22 offset:9216
  v_mfma_f32_16x16x32_bf16 v[44:47], v[160:163], v[156:159], v[44:47]
  ds_read_b128 v[192:195], v15 offset:2048
  v_mfma_f32_16x16x32_bf16 v[80:83], v[172:175], v[144:147], v[80:83]
  ds_read_b128 v[196:199], v15 offset:4096
  v_mfma_f32_16x16x32_bf16 v[84:87], v[172:175], v[148:151], v[84:87]
  ds_read_b128 v[200:203], v15 offset:6144
  v_mfma_f32_16x16x32_bf16 v[88:91], v[172:175], v[152:155], v[88:91]
  ds_read_b64_tr_b16 v[216:217], v22 offset:24576
  v_mfma_f32_16x16x32_bf16 v[92:95], v[172:175], v[156:159], v[92:95]
  ds_read_b64_tr_b16 v[218:219], v22 offset:25600
  v_mfma_f32_16x16x32_bf16 v[48:51], v[164:167], v[144:147], v[48:51]
  ds_read_b64_tr_b16 v[208:209], v23 offset:8192
  v_mfma_f32_16x16x32_bf16 v[52:55], v[164:167], v[148:151], v[52:55]
  ds_read_b64_tr_b16 v[210:211], v23 offset:9216
  v_mfma_f32_16x16x32_bf16 v[56:59], v[164:167], v[152:155], v[56:59]
  ds_read_b64_tr_b16 v[220:221], v23 offset:24576
  v_mfma_f32_16x16x32_bf16 v[60:63], v[164:167], v[156:159], v[60:63]
  ds_read_b64_tr_b16 v[222:223], v23 offset:25600
  v_mfma_f32_16x16x32_bf16 v[96:99], v[176:179], v[144:147], v[96:99]
  ds_read_b64_tr_b16 v[212:213], v24 offset:8192
  v_mfma_f32_16x16x32_bf16 v[100:103], v[176:179], v[148:151], v[100:103]
  ds_read_b64_tr_b16 v[214:215], v24 offset:9216
  v_mfma_f32_16x16x32_bf16 v[104:107], v[176:179], v[152:155], v[104:107]
  ds_read_b64_tr_b16 v[224:225], v24 offset:24576
  v_mfma_f32_16x16x32_bf16 v[108:111], v[176:179], v[156:159], v[108:111]
  ds_read_b64_tr_b16 v[226:227], v24 offset:25600
  v_mfma_f32_16x16x32_bf16 v[64:67], v[168:171], v[144:147], v[64:67]
  ds_read_b64_tr_b16 v[228:229], v25 offset:8192
  v_mfma_f32_16x16x32_bf16 v[68:71], v[168:171], v[148:151], v[68:71]
  ds_read_b64_tr_b16 v[230:231], v25 offset:9216
  v_mfma_f32_16x16x32_bf16 v[72:75], v[168:171], v[152:155], v[72:75]
  v_mfma_f32_16x16x32_bf16 v[76:79], v[168:171], v[156:159], v[76:79]
  v_mfma_f32_16x16x32_bf16 v[112:115], v[180:183], v[144:147], v[112:115]
  v_mfma_f32_16x16x32_bf16 v[116:119], v[180:183], v[148:151], v[116:119]
  v_mfma_f32_16x16x32_bf16 v[120:123], v[180:183], v[152:155], v[120:123]
  v_mfma_f32_16x16x32_bf16 v[124:127], v[180:183], v[156:159], v[124:127]
  v_mfma_f32_16x16x32_bf16 v[128:131], v[184:187], v[144:147], v[128:131]
  v_mfma_f32_16x16x32_bf16 v[132:135], v[184:187], v[148:151], v[132:135]
  v_mfma_f32_16x16x32_bf16 v[136:139], v[184:187], v[152:155], v[136:139]
  v_mfma_f32_16x16x32_bf16 v[140:143], v[184:187], v[156:159], v[140:143]
  s_waitcnt lgkmcnt(0)
  s_barrier
  v_mfma_f32_16x16x32_bf16 v[32:35], v[204:207], v[188:191], v[32:35]
  ds_read_b128 v[144:147], v16 offset:0
  v_mfma_f32_16x16x32_bf16 v[36:39], v[204:207], v[192:195], v[36:39]
  ds_read_b64_tr_b16 v[160:161], v26 offset:0
  v_mfma_f32_16x16x32_bf16 v[40:43], v[204:207], v[196:199], v[40:43]
  ds_read_b64_tr_b16 v[162:163], v26 offset:1024
  v_mfma_f32_16x16x32_bf16 v[44:47], v[204:207], v[200:203], v[44:47]
  ds_read_b128 v[148:151], v16 offset:2048
  v_mfma_f32_16x16x32_bf16 v[80:83], v[216:219], v[188:191], v[80:83]
  ds_read_b128 v[152:155], v16 offset:4096
  v_mfma_f32_16x16x32_bf16 v[84:87], v[216:219], v[192:195], v[84:87]
  ds_read_b128 v[156:159], v16 offset:6144
  v_mfma_f32_16x16x32_bf16 v[88:91], v[216:219], v[196:199], v[88:91]
  ds_read_b64_tr_b16 v[172:173], v26 offset:16384
  v_mfma_f32_16x16x32_bf16 v[92:95], v[216:219], v[200:203], v[92:95]
  ds_read_b64_tr_b16 v[174:175], v26 offset:17408
  v_mfma_f32_16x16x32_bf16 v[48:51], v[208:211], v[188:191], v[48:51]
  ds_read_b64_tr_b16 v[164:165], v27 offset:0
  v_mfma_f32_16x16x32_bf16 v[52:55], v[208:211], v[192:195], v[52:55]
  ds_read_b64_tr_b16 v[166:167], v27 offset:1024
  v_mfma_f32_16x16x32_bf16 v[56:59], v[208:211], v[196:199], v[56:59]
  ds_read_b64_tr_b16 v[176:177], v27 offset:16384
  v_mfma_f32_16x16x32_bf16 v[60:63], v[208:211], v[200:203], v[60:63]
  ds_read_b64_tr_b16 v[178:179], v27 offset:17408
  v_mfma_f32_16x16x32_bf16 v[96:99], v[220:223], v[188:191], v[96:99]
  ds_read_b64_tr_b16 v[168:169], v28 offset:0
  v_mfma_f32_16x16x32_bf16 v[100:103], v[220:223], v[192:195], v[100:103]
  ds_read_b64_tr_b16 v[170:171], v28 offset:1024
  v_mfma_f32_16x16x32_bf16 v[104:107], v[220:223], v[196:199], v[104:107]
  ds_read_b64_tr_b16 v[180:181], v28 offset:16384
  v_mfma_f32_16x16x32_bf16 v[108:111], v[220:223], v[200:203], v[108:111]
  ds_read_b64_tr_b16 v[182:183], v28 offset:17408
  v_mfma_f32_16x16x32_bf16 v[64:67], v[212:215], v[188:191], v[64:67]
  ds_read_b64_tr_b16 v[184:185], v29 offset:0
  v_mfma_f32_16x16x32_bf16 v[68:71], v[212:215], v[192:195], v[68:71]
  ds_read_b64_tr_b16 v[186:187], v29 offset:1024
  v_mfma_f32_16x16x32_bf16 v[72:75], v[212:215], v[196:199], v[72:75]
  v_mfma_f32_16x16x32_bf16 v[76:79], v[212:215], v[200:203], v[76:79]
  v_mfma_f32_16x16x32_bf16 v[112:115], v[224:227], v[188:191], v[112:115]
  v_mfma_f32_16x16x32_bf16 v[116:119], v[224:227], v[192:195], v[116:119]
  v_mfma_f32_16x16x32_bf16 v[120:123], v[224:227], v[196:199], v[120:123]
  v_mfma_f32_16x16x32_bf16 v[124:127], v[224:227], v[200:203], v[124:127]
  v_mfma_f32_16x16x32_bf16 v[128:131], v[228:231], v[188:191], v[128:131]
  v_mfma_f32_16x16x32_bf16 v[132:135], v[228:231], v[192:195], v[132:135]
  v_mfma_f32_16x16x32_bf16 v[136:139], v[228:231], v[196:199], v[136:139]
  v_mfma_f32_16x16x32_bf16 v[140:143], v[228:231], v[200:203], v[140:143]
  s_waitcnt lgkmcnt(0)
  v_mfma_f32_16x16x32_bf16 v[32:35], v[160:163], v[144:147], v[32:35]
  ds_read_b128 v[188:191], v17 offset:0
  v_mfma_f32_16x16x32_bf16 v[36:39], v[160:163], v[148:151], v[36:39]
  ds_read_b64_tr_b16 v[204:205], v26 offset:8192
  v_mfma_f32_16x16x32_bf16 v[40:43], v[160:163], v[152:155], v[40:43]
  ds_read_b64_tr_b16 v[206:207], v26 offset:9216
  v_mfma_f32_16x16x32_bf16 v[44:47], v[160:163], v[156:159], v[44:47]
  ds_read_b128 v[192:195], v17 offset:2048
  v_mfma_f32_16x16x32_bf16 v[80:83], v[172:175], v[144:147], v[80:83]
  ds_read_b128 v[196:199], v17 offset:4096
  v_mfma_f32_16x16x32_bf16 v[84:87], v[172:175], v[148:151], v[84:87]
  ds_read_b128 v[200:203], v17 offset:6144
  v_mfma_f32_16x16x32_bf16 v[88:91], v[172:175], v[152:155], v[88:91]
  ds_read_b64_tr_b16 v[216:217], v26 offset:24576
  v_mfma_f32_16x16x32_bf16 v[92:95], v[172:175], v[156:159], v[92:95]
  ds_read_b64_tr_b16 v[218:219], v26 offset:25600
  v_mfma_f32_16x16x32_bf16 v[48:51], v[164:167], v[144:147], v[48:51]
  ds_read_b64_tr_b16 v[208:209], v27 offset:8192
  v_mfma_f32_16x16x32_bf16 v[52:55], v[164:167], v[148:151], v[52:55]
  ds_read_b64_tr_b16 v[210:211], v27 offset:9216
  v_mfma_f32_16x16x32_bf16 v[56:59], v[164:167], v[152:155], v[56:59]
  ds_read_b64_tr_b16 v[220:221], v27 offset:24576
  v_mfma_f32_16x16x32_bf16 v[60:63], v[164:167], v[156:159], v[60:63]
  ds_read_b64_tr_b16 v[222:223], v27 offset:25600
  v_mfma_f32_16x16x32_bf16 v[96:99], v[176:179], v[144:147], v[96:99]
  ds_read_b64_tr_b16 v[212:213], v28 offset:8192
  v_mfma_f32_16x16x32_bf16 v[100:103], v[176:179], v[148:151], v[100:103]
  ds_read_b64_tr_b16 v[214:215], v28 offset:9216
  v_mfma_f32_16x16x32_bf16 v[104:107], v[176:179], v[152:155], v[104:107]
  ds_read_b64_tr_b16 v[224:225], v28 offset:24576
  v_mfma_f32_16x16x32_bf16 v[108:111], v[176:179], v[156:159], v[108:111]
  ds_read_b64_tr_b16 v[226:227], v28 offset:25600
  v_mfma_f32_16x16x32_bf16 v[64:67], v[168:171], v[144:147], v[64:67]
  ds_read_b64_tr_b16 v[228:229], v29 offset:8192
  v_mfma_f32_16x16x32_bf16 v[68:71], v[168:171], v[148:151], v[68:71]
  ds_read_b64_tr_b16 v[230:231], v29 offset:9216
  v_mfma_f32_16x16x32_bf16 v[72:75], v[168:171], v[152:155], v[72:75]
  v_mfma_f32_16x16x32_bf16 v[76:79], v[168:171], v[156:159], v[76:79]
  v_mfma_f32_16x16x32_bf16 v[112:115], v[180:183], v[144:147], v[112:115]
  v_mfma_f32_16x16x32_bf16 v[116:119], v[180:183], v[148:151], v[116:119]
  v_mfma_f32_16x16x32_bf16 v[120:123], v[180:183], v[152:155], v[120:123]
  v_mfma_f32_16x16x32_bf16 v[124:127], v[180:183], v[156:159], v[124:127]
  v_mfma_f32_16x16x32_bf16 v[128:131], v[184:187], v[144:147], v[128:131]
  v_mfma_f32_16x16x32_bf16 v[132:135], v[184:187], v[148:151], v[132:135]
  v_mfma_f32_16x16x32_bf16 v[136:139], v[184:187], v[152:155], v[136:139]
  v_mfma_f32_16x16x32_bf16 v[140:143], v[184:187], v[156:159], v[140:143]
  s_waitcnt lgkmcnt(0)
  s_barrier
  v_mfma_f32_16x16x32_bf16 v[32:35], v[204:207], v[188:191], v[32:35]
  ds_read_b128 v[144:147], v12 offset:0
  v_mfma_f32_16x16x32_bf16 v[36:39], v[204:207], v[192:195], v[36:39]
  ds_read_b64_tr_b16 v[160:161], v18 offset:0
  v_mfma_f32_16x16x32_bf16 v[40:43], v[204:207], v[196:199], v[40:43]
  ds_read_b64_tr_b16 v[162:163], v18 offset:1024
  v_mfma_f32_16x16x32_bf16 v[44:47], v[204:207], v[200:203], v[44:47]
  ds_read_b128 v[148:151], v12 offset:2048
  v_mfma_f32_16x16x32_bf16 v[80:83], v[216:219], v[188:191], v[80:83]
  ds_read_b128 v[152:155], v12 offset:4096
  v_mfma_f32_16x16x32_bf16 v[84:87], v[216:219], v[192:195], v[84:87]
  ds_read_b128 v[156:159], v12 offset:6144
  v_mfma_f32_16x16x32_bf16 v[88:91], v[216:219], v[196:199], v[88:91]
  ds_read_b64_tr_b16 v[172:173], v18 offset:16384
  v_mfma_f32_16x16x32_bf16 v[92:95], v[216:219], v[200:203], v[92:95]
  ds_read_b64_tr_b16 v[174:175], v18 offset:17408
  v_mfma_f32_16x16x32_bf16 v[48:51], v[208:211], v[188:191], v[48:51]
  ds_read_b64_tr_b16 v[164:165], v19 offset:0
  v_mfma_f32_16x16x32_bf16 v[52:55], v[208:211], v[192:195], v[52:55]
  ds_read_b64_tr_b16 v[166:167], v19 offset:1024
  v_mfma_f32_16x16x32_bf16 v[56:59], v[208:211], v[196:199], v[56:59]
  ds_read_b64_tr_b16 v[176:177], v19 offset:16384
  v_mfma_f32_16x16x32_bf16 v[60:63], v[208:211], v[200:203], v[60:63]
  ds_read_b64_tr_b16 v[178:179], v19 offset:17408
  v_mfma_f32_16x16x32_bf16 v[96:99], v[220:223], v[188:191], v[96:99]
  ds_read_b64_tr_b16 v[168:169], v20 offset:0
  v_mfma_f32_16x16x32_bf16 v[100:103], v[220:223], v[192:195], v[100:103]
  ds_read_b64_tr_b16 v[170:171], v20 offset:1024
  v_mfma_f32_16x16x32_bf16 v[104:107], v[220:223], v[196:199], v[104:107]
  ds_read_b64_tr_b16 v[180:181], v20 offset:16384
  v_mfma_f32_16x16x32_bf16 v[108:111], v[220:223], v[200:203], v[108:111]
  ds_read_b64_tr_b16 v[182:183], v20 offset:17408
  v_mfma_f32_16x16x32_bf16 v[64:67], v[212:215], v[188:191], v[64:67]
  ds_read_b64_tr_b16 v[184:185], v21 offset:0
  v_mfma_f32_16x16x32_bf16 v[68:71], v[212:215], v[192:195], v[68:71]
  ds_read_b64_tr_b16 v[186:187], v21 offset:1024
  v_mfma_f32_16x16x32_bf16 v[72:75], v[212:215], v[196:199], v[72:75]
  v_mfma_f32_16x16x32_bf16 v[76:79], v[212:215], v[200:203], v[76:79]
  v_mfma_f32_16x16x32_bf16 v[112:115], v[224:227], v[188:191], v[112:115]
  v_mfma_f32_16x16x32_bf16 v[116:119], v[224:227], v[192:195], v[116:119]
  v_mfma_f32_16x16x32_bf16 v[120:123], v[224:227], v[196:199], v[120:123]
  v_mfma_f32_16x16x32_bf16 v[124:127], v[224:227], v[200:203], v[124:127]
  v_mfma_f32_16x16x32_bf16 v[128:131], v[228:231], v[188:191], v[128:131]
  v_mfma_f32_16x16x32_bf16 v[132:135], v[228:231], v[192:195], v[132:135]
  v_mfma_f32_16x16x32_bf16 v[136:139], v[228:231], v[196:199], v[136:139]
  v_mfma_f32_16x16x32_bf16 v[140:143], v[228:231], v[200:203], v[140:143]
  s_waitcnt lgkmcnt(0)
  v_mfma_f32_16x16x32_bf16 v[32:35], v[160:163], v[144:147], v[32:35]
  ds_read_b128 v[188:191], v13 offset:0
  v_mfma_f32_16x16x32_bf16 v[36:39], v[160:163], v[148:151], v[36:39]
  ds_read_b64_tr_b16 v[204:205], v18 offset:8192
  v_mfma_f32_16x16x32_bf16 v[40:43], v[160:163], v[152:155], v[40:43]
  ds_read_b64_tr_b16 v[206:207], v18 offset:9216
  v_mfma_f32_16x16x32_bf16 v[44:47], v[160:163], v[156:159], v[44:47]
  ds_read_b128 v[192:195], v13 offset:2048
  v_mfma_f32_16x16x32_bf16 v[80:83], v[172:175], v[144:147], v[80:83]
  ds_read_b128 v[196:199], v13 offset:4096
  v_mfma_f32_16x16x32_bf16 v[84:87], v[172:175], v[148:151], v[84:87]
  ds_read_b128 v[200:203], v13 offset:6144
  v_mfma_f32_16x16x32_bf16 v[88:91], v[172:175], v[152:155], v[88:91]
  ds_read_b64_tr_b16 v[216:217], v18 offset:24576
  v_mfma_f32_16x16x32_bf16 v[92:95], v[172:175], v[156:159], v[92:95]
  ds_read_b64_tr_b16 v[218:219], v18 offset:25600
  v_mfma_f32_16x16x32_bf16 v[48:51], v[164:167], v[144:147], v[48:51]
  ds_read_b64_tr_b16 v[208:209], v19 offset:8192
  v_mfma_f32_16x16x32_bf16 v[52:55], v[164:167], v[148:151], v[52:55]
  ds_read_b64_tr_b16 v[210:211], v19 offset:9216
  v_mfma_f32_16x16x32_bf16 v[56:59], v[164:167], v[152:155], v[56:59]
  ds_read_b64_tr_b16 v[220:221], v19 offset:24576
  v_mfma_f32_16x16x32_bf16 v[60:63], v[164:167], v[156:159], v[60:63]
  ds_read_b64_tr_b16 v[222:223], v19 offset:25600
  v_mfma_f32_16x16x32_bf16 v[96:99], v[176:179], v[144:147], v[96:99]
  ds_read_b64_tr_b16 v[212:213], v20 offset:8192
  v_mfma_f32_16x16x32_bf16 v[100:103], v[176:179], v[148:151], v[100:103]
  ds_read_b64_tr_b16 v[214:215], v20 offset:9216
  v_mfma_f32_16x16x32_bf16 v[104:107], v[176:179], v[152:155], v[104:107]
  ds_read_b64_tr_b16 v[224:225], v20 offset:24576
  v_mfma_f32_16x16x32_bf16 v[108:111], v[176:179], v[156:159], v[108:111]
  ds_read_b64_tr_b16 v[226:227], v20 offset:25600
  v_mfma_f32_16x16x32_bf16 v[64:67], v[168:171], v[144:147], v[64:67]
  ds_read_b64_tr_b16 v[228:229], v21 offset:8192
  v_mfma_f32_16x16x32_bf16 v[68:71], v[168:171], v[148:151], v[68:71]
  ds_read_b64_tr_b16 v[230:231], v21 offset:9216
  v_mfma_f32_16x16x32_bf16 v[72:75], v[168:171], v[152:155], v[72:75]
  v_mfma_f32_16x16x32_bf16 v[76:79], v[168:171], v[156:159], v[76:79]
  v_mfma_f32_16x16x32_bf16 v[112:115], v[180:183], v[144:147], v[112:115]
  v_mfma_f32_16x16x32_bf16 v[116:119], v[180:183], v[148:151], v[116:119]
  v_mfma_f32_16x16x32_bf16 v[120:123], v[180:183], v[152:155], v[120:123]
  v_mfma_f32_16x16x32_bf16 v[124:127], v[180:183], v[156:159], v[124:127]
  v_mfma_f32_16x16x32_bf16 v[128:131], v[184:187], v[144:147], v[128:131]
  v_mfma_f32_16x16x32_bf16 v[132:135], v[184:187], v[148:151], v[132:135]
  v_mfma_f32_16x16x32_bf16 v[136:139], v[184:187], v[152:155], v[136:139]
  v_mfma_f32_16x16x32_bf16 v[140:143], v[184:187], v[156:159], v[140:143]
  s_waitcnt lgkmcnt(0)
  s_barrier
  v_mfma_f32_16x16x32_bf16 v[32:35], v[204:207], v[188:191], v[32:35]
  ds_read_b128 v[144:147], v14 offset:0
  v_mfma_f32_16x16x32_bf16 v[36:39], v[204:207], v[192:195], v[36:39]
  ds_read_b64_tr_b16 v[160:161], v22 offset:0
  v_mfma_f32_16x16x32_bf16 v[40:43], v[204:207], v[196:199], v[40:43]
  ds_read_b64_tr_b16 v[162:163], v22 offset:1024
  v_mfma_f32_16x16x32_bf16 v[44:47], v[204:207], v[200:203], v[44:47]
  ds_read_b128 v[148:151], v14 offset:2048
  v_mfma_f32_16x16x32_bf16 v[80:83], v[216:219], v[188:191], v[80:83]
  ds_read_b128 v[152:155], v14 offset:4096
  v_mfma_f32_16x16x32_bf16 v[84:87], v[216:219], v[192:195], v[84:87]
  ds_read_b128 v[156:159], v14 offset:6144
  v_mfma_f32_16x16x32_bf16 v[88:91], v[216:219], v[196:199], v[88:91]
  ds_read_b64_tr_b16 v[172:173], v22 offset:16384
  v_mfma_f32_16x16x32_bf16 v[92:95], v[216:219], v[200:203], v[92:95]
  ds_read_b64_tr_b16 v[174:175], v22 offset:17408
  v_mfma_f32_16x16x32_bf16 v[48:51], v[208:211], v[188:191], v[48:51]
  ds_read_b64_tr_b16 v[164:165], v23 offset:0
  v_mfma_f32_16x16x32_bf16 v[52:55], v[208:211], v[192:195], v[52:55]
  ds_read_b64_tr_b16 v[166:167], v23 offset:1024
  v_mfma_f32_16x16x32_bf16 v[56:59], v[208:211], v[196:199], v[56:59]
  ds_read_b64_tr_b16 v[176:177], v23 offset:16384
  v_mfma_f32_16x16x32_bf16 v[60:63], v[208:211], v[200:203], v[60:63]
  ds_read_b64_tr_b16 v[178:179], v23 offset:17408
  v_mfma_f32_16x16x32_bf16 v[96:99], v[220:223], v[188:191], v[96:99]
  ds_read_b64_tr_b16 v[168:169], v24 offset:0
  v_mfma_f32_16x16x32_bf16 v[100:103], v[220:223], v[192:195], v[100:103]
  ds_read_b64_tr_b16 v[170:171], v24 offset:1024
  v_mfma_f32_16x16x32_bf16 v[104:107], v[220:223], v[196:199], v[104:107]
  ds_read_b64_tr_b16 v[180:181], v24 offset:16384
  v_mfma_f32_16x16x32_bf16 v[108:111], v[220:223], v[200:203], v[108:111]
  ds_read_b64_tr_b16 v[182:183], v24 offset:17408
  v_mfma_f32_16x16x32_bf16 v[64:67], v[212:215], v[188:191], v[64:67]
  ds_read_b64_tr_b16 v[184:185], v25 offset:0
  v_mfma_f32_16x16x32_bf16 v[68:71], v[212:215], v[192:195], v[68:71]
  ds_read_b64_tr_b16 v[186:187], v25 offset:1024
  v_mfma_f32_16x16x32_bf16 v[72:75], v[212:215], v[196:199], v[72:75]
  v_mfma_f32_16x16x32_bf16 v[76:79], v[212:215], v[200:203], v[76:79]
  v_mfma_f32_16x16x32_bf16 v[112:115], v[224:227], v[188:191], v[112:115]
  v_mfma_f32_16x16x32_bf16 v[116:119], v[224:227], v[192:195], v[116:119]
  v_mfma_f32_16x16x32_bf16 v[120:123], v[224:227], v[196:199], v[120:123]
  v_mfma_f32_16x16x32_bf16 v[124:127], v[224:227], v[200:203], v[124:127]
  v_mfma_f32_16x16x32_bf16 v[128:131], v[228:231], v[188:191], v[128:131]
  v_mfma_f32_16x16x32_bf16 v[132:135], v[228:231], v[192:195], v[132:135]
  v_mfma_f32_16x16x32_bf16 v[136:139], v[228:231], v[196:199], v[136:139]
  v_mfma_f32_16x16x32_bf16 v[140:143], v[228:231], v[200:203], v[140:143]
  s_waitcnt lgkmcnt(0)
  v_mfma_f32_16x16x32_bf16 v[32:35], v[160:163], v[144:147], v[32:35]
  ds_read_b128 v[188:191], v15 offset:0
  v_mfma_f32_16x16x32_bf16 v[36:39], v[160:163], v[148:151], v[36:39]
  ds_read_b64_tr_b16 v[204:205], v22 offset:8192
  v_mfma_f32_16x16x32_bf16 v[40:43], v[160:163], v[152:155], v[40:43]
  ds_read_b64_tr_b16 v[206:207], v22 offset:9216
  v_mfma_f32_16x16x32_bf16 v[44:47], v[160:163], v[156:159], v[44:47]
  ds_read_b128 v[192:195], v15 offset:2048
  v_mfma_f32_16x16x32_bf16 v[80:83], v[172:175], v[144:147], v[80:83]
  ds_read_b128 v[196:199], v15 offset:4096
  v_mfma_f32_16x16x32_bf16 v[84:87], v[172:175], v[148:151], v[84:87]
  ds_read_b128 v[200:203], v15 offset:6144
  v_mfma_f32_16x16x32_bf16 v[88:91], v[172:175], v[152:155], v[88:91]
  ds_read_b64_tr_b16 v[216:217], v22 offset:24576
  v_mfma_f32_16x16x32_bf16 v[92:95], v[172:175], v[156:159], v[92:95]
  ds_read_b64_tr_b16 v[218:219], v22 offset:25600
  v_mfma_f32_16x16x32_bf16 v[48:51], v[164:167], v[144:147], v[48:51]
  ds_read_b64_tr_b16 v[208:209], v23 offset:8192
  v_mfma_f32_16x16x32_bf16 v[52:55], v[164:167], v[148:151], v[52:55]
  ds_read_b64_tr_b16 v[210:211], v23 offset:9216
  v_mfma_f32_16x16x32_bf16 v[56:59], v[164:167], v[152:155], v[56:59]
  ds_read_b64_tr_b16 v[220:221], v23 offset:24576
  v_mfma_f32_16x16x32_bf16 v[60:63], v[164:167], v[156:159], v[60:63]
  ds_read_b64_tr_b16 v[222:223], v23 offset:25600
  v_mfma_f32_16x16x32_bf16 v[96:99], v[176:179], v[144:147], v[96:99]
  ds_read_b64_tr_b16 v[212:213], v24 offset:8192
  v_mfma_f32_16x16x32_bf16 v[100:103], v[176:179], v[148:151], v[100:103]
  ds_read_b64_tr_b16 v[214:215], v24 offset:9216
  v_mfma_f32_16x16x32_bf16 v[104:107], v[176:179], v[152:155], v[104:107]
  ds_read_b64_tr_b16 v[224:225], v24 offset:24576
  v_mfma_f32_16x16x32_bf16 v[108:111], v[176:179], v[156:159], v[108:111]
  ds_read_b64_tr_b16 v[226:227], v24 offset:25600
  v_mfma_f32_16x16x32_bf16 v[64:67], v[168:171], v[144:147], v[64:67]
  ds_read_b64_tr_b16 v[228:229], v25 offset:8192
  v_mfma_f32_16x16x32_bf16 v[68:71], v[168:171], v[148:151], v[68:71]
  ds_read_b64_tr_b16 v[230:231], v25 offset:9216
  v_mfma_f32_16x16x32_bf16 v[72:75], v[168:171], v[152:155], v[72:75]
  v_mfma_f32_16x16x32_bf16 v[76:79], v[168:171], v[156:159], v[76:79]
  v_mfma_f32_16x16x32_bf16 v[112:115], v[180:183], v[144:147], v[112:115]
  v_mfma_f32_16x16x32_bf16 v[116:119], v[180:183], v[148:151], v[116:119]
  v_mfma_f32_16x16x32_bf16 v[120:123], v[180:183], v[152:155], v[120:123]
  v_mfma_f32_16x16x32_bf16 v[124:127], v[180:183], v[156:159], v[124:127]
  v_mfma_f32_16x16x32_bf16 v[128:131], v[184:187], v[144:147], v[128:131]
  v_mfma_f32_16x16x32_bf16 v[132:135], v[184:187], v[148:151], v[132:135]
  v_mfma_f32_16x16x32_bf16 v[136:139], v[184:187], v[152:155], v[136:139]
  v_mfma_f32_16x16x32_bf16 v[140:143], v[184:187], v[156:159], v[140:143]
  s_waitcnt lgkmcnt(0)
  v_mfma_f32_16x16x32_bf16 v[32:35], v[204:207], v[188:191], v[32:35]
  v_mfma_f32_16x16x32_bf16 v[36:39], v[204:207], v[192:195], v[36:39]
  v_mfma_f32_16x16x32_bf16 v[40:43], v[204:207], v[196:199], v[40:43]
  v_mfma_f32_16x16x32_bf16 v[44:47], v[204:207], v[200:203], v[44:47]
  v_mfma_f32_16x16x32_bf16 v[80:83], v[216:219], v[188:191], v[80:83]
  v_mfma_f32_16x16x32_bf16 v[84:87], v[216:219], v[192:195], v[84:87]
  v_mfma_f32_16x16x32_bf16 v[88:91], v[216:219], v[196:199], v[88:91]
  v_mfma_f32_16x16x32_bf16 v[92:95], v[216:219], v[200:203], v[92:95]
  v_mfma_f32_16x16x32_bf16 v[48:51], v[208:211], v[188:191], v[48:51]
  v_mfma_f32_16x16x32_bf16 v[52:55], v[208:211], v[192:195], v[52:55]
  v_mfma_f32_16x16x32_bf16 v[56:59], v[208:211], v[196:199], v[56:59]
  v_mfma_f32_16x16x32_bf16 v[60:63], v[208:211], v[200:203], v[60:63]
  v_mfma_f32_16x16x32_bf16 v[96:99], v[220:223], v[188:191], v[96:99]
  v_mfma_f32_16x16x32_bf16 v[100:103], v[220:223], v[192:195], v[100:103]
  v_mfma_f32_16x16x32_bf16 v[104:107], v[220:223], v[196:199], v[104:107]
  v_mfma_f32_16x16x32_bf16 v[108:111], v[220:223], v[200:203], v[108:111]
  v_mfma_f32_16x16x32_bf16 v[64:67], v[212:215], v[188:191], v[64:67]
  v_mfma_f32_16x16x32_bf16 v[68:71], v[212:215], v[192:195], v[68:71]
  v_mfma_f32_16x16x32_bf16 v[72:75], v[212:215], v[196:199], v[72:75]
  v_mfma_f32_16x16x32_bf16 v[76:79], v[212:215], v[200:203], v[76:79]
  v_mfma_f32_16x16x32_bf16 v[112:115], v[224:227], v[188:191], v[112:115]
  v_mfma_f32_16x16x32_bf16 v[116:119], v[224:227], v[192:195], v[116:119]
  v_mfma_f32_16x16x32_bf16 v[120:123], v[224:227], v[196:199], v[120:123]
  v_mfma_f32_16x16x32_bf16 v[124:127], v[224:227], v[200:203], v[124:127]
  v_mfma_f32_16x16x32_bf16 v[128:131], v[228:231], v[188:191], v[128:131]
  v_mfma_f32_16x16x32_bf16 v[132:135], v[228:231], v[192:195], v[132:135]
  v_mfma_f32_16x16x32_bf16 v[136:139], v[228:231], v[196:199], v[136:139]
  v_mfma_f32_16x16x32_bf16 v[140:143], v[228:231], v[200:203], v[140:143]
  s_barrier
  ds_read_b128 v[144:147], v232 offset:0
  ds_read_b128 v[148:151], v232 offset:256
  ds_read_b128 v[152:155], v232 offset:512
  ds_read_b128 v[156:159], v232 offset:768
  ds_read_b128 v[168:171], v234 offset:0
  ds_read_b128 v[180:183], v234 offset:448
  ds_read_b128 v[172:175], v234 offset:64
  ds_read_b128 v[184:187], v234 offset:512
  ds_read_b128 v[176:179], v234 offset:128
  ds_read_b128 v[188:191], v234 offset:576
  ds_read_b128 v[160:163], v233 offset:0
  ds_read_b128 v[164:167], v233 offset:512
  ds_read_b128 v[192:195], v235 offset:192
  ds_read_b128 v[196:199], v235 offset:640
  v_permlane32_swap_b32 v128, v132
  v_permlane32_swap_b32 v129, v133
  v_permlane32_swap_b32 v130, v134
  v_permlane32_swap_b32 v131, v135
  v_permlane32_swap_b32 v136, v140
  v_permlane32_swap_b32 v137, v141
  v_permlane32_swap_b32 v138, v142
  v_permlane32_swap_b32 v139, v143
  s_waitcnt lgkmcnt(0)
  v_pk_fma_f32 v[32:33], v[168:169], v[144:145], v[32:33] op_sel_hi:[1,0,1] neg_lo:[0,1,0] neg_hi:[0,1,0]
  v_pk_fma_f32 v[34:35], v[170:171], v[144:145], v[34:35] op_sel_hi:[1,0,1] neg_lo:[0,1,0] neg_hi:[0,1,0]
  v_pk_fma_f32 v[36:37], v[168:169], v[148:149], v[36:37] op_sel_hi:[1,0,1] neg_lo:[0,1,0] neg_hi:[0,1,0]
  v_pk_fma_f32 v[38:39], v[170:171], v[148:149], v[38:39] op_sel_hi:[1,0,1] neg_lo:[0,1,0] neg_hi:[0,1,0]
  v_pk_fma_f32 v[48:49], v[172:173], v[144:145], v[48:49] op_sel_hi:[1,0,1] neg_lo:[0,1,0] neg_hi:[0,1,0]
  v_pk_fma_f32 v[50:51], v[174:175], v[144:145], v[50:51] op_sel_hi:[1,0,1] neg_lo:[0,1,0] neg_hi:[0,1,0]
  v_pk_fma_f32 v[52:53], v[172:173], v[148:149], v[52:53] op_sel_hi:[1,0,1] neg_lo:[0,1,0] neg_hi:[0,1,0]
  v_pk_fma_f32 v[54:55], v[174:175], v[148:149], v[54:55] op_sel_hi:[1,0,1] neg_lo:[0,1,0] neg_hi:[0,1,0]
  v_pk_mul_f32 v[200:201], v[32:33], v[32:33]
  v_pk_mul_f32 v[202:203], v[34:35], v[34:35]
  v_pk_mul_f32 v[204:205], v[36:37], v[36:37]
  v_pk_mul_f32 v[206:207], v[38:39], v[38:39]
  v_pk_mul_f32 v[208:209], v[48:49], v[48:49]
  v_pk_mul_f32 v[210:211], v[50:51], v[50:51]
  v_pk_mul_f32 v[212:213], v[52:53], v[52:53]
  v_pk_mul_f32 v[214:215], v[54:55], v[54:55]
  v_pk_fma_f32 v[200:201], v[200:201], v[146:147], v[144:145] op_sel:[0,0,1] op_sel_hi:[1,0,1]
  v_pk_fma_f32 v[202:203], v[202:203], v[146:147], v[144:145] op_sel:[0,0,1] op_sel_hi:[1,0,1]
  v_pk_fma_f32 v[204:205], v[204:205], v[150:151], v[148:149] op_sel:[0,0,1] op_sel_hi:[1,0,1]
  v_pk_fma_f32 v[206:207], v[206:207], v[150:151], v[148:149] op_sel:[0,0,1] op_sel_hi:[1,0,1]
  v_pk_fma_f32 v[208:209], v[208:209], v[146:147], v[144:145] op_sel:[0,0,1] op_sel_hi:[1,0,1]
  v_pk_fma_f32 v[210:211], v[210:211], v[146:147], v[144:145] op_sel:[0,0,1] op_sel_hi:[1,0,1]
  v_pk_fma_f32 v[212:213], v[212:213], v[150:151], v[148:149] op_sel:[0,0,1] op_sel_hi:[1,0,1]
  v_pk_fma_f32 v[214:215], v[214:215], v[150:151], v[148:149] op_sel:[0,0,1] op_sel_hi:[1,0,1]
  v_pk_mul_f32 v[200:201], v[200:201], v[32:33]
  v_pk_mul_f32 v[202:203], v[202:203], v[34:35]
  v_pk_mul_f32 v[204:205], v[204:205], v[36:37]
  v_pk_mul_f32 v[206:207], v[206:207], v[38:39]
  v_pk_mul_f32 v[208:209], v[208:209], v[48:49]
  v_pk_mul_f32 v[210:211], v[210:211], v[50:51]
  v_pk_mul_f32 v[212:213], v[212:213], v[52:53]
  v_pk_mul_f32 v[214:215], v[214:215], v[54:55]
  v_exp_f32 v200, v200
  v_exp_f32 v201, v201
  v_exp_f32 v202, v202
  v_exp_f32 v203, v203
  v_exp_f32 v204, v204
  v_exp_f32 v205, v205
  v_exp_f32 v206, v206
  v_exp_f32 v207, v207
  v_exp_f32 v208, v208
  v_exp_f32 v209, v209
  v_exp_f32 v210, v210
  v_exp_f32 v211, v211
  v_exp_f32 v212, v212
  v_exp_f32 v213, v213
  v_exp_f32 v214, v214
  v_exp_f32 v215, v215
  v_pk_fma_f32 v[80:81], v[180:181], v[144:145], v[80:81] op_sel_hi:[1,0,1] neg_lo:[0,1,0] neg_hi:[0,1,0]
  v_pk_fma_f32 v[82:83], v[182:183], v[144:145], v[82:83] op_sel_hi:[1,0,1] neg_lo:[0,1,0] neg_hi:[0,1,0]
  v_pk_fma_f32 v[84:85], v[180:181], v[148:149], v[84:85] op_sel_hi:[1,0,1] neg_lo:[0,1,0] neg_hi:[0,1,0]
  v_pk_fma_f32 v[86:87], v[182:183], v[148:149], v[86:87] op_sel_hi:[1,0,1] neg_lo:[0,1,0] neg_hi:[0,1,0]
  v_pk_fma_f32 v[96:97], v[184:185], v[144:145], v[96:97] op_sel_hi:[1,0,1] neg_lo:[0,1,0] neg_hi:[0,1,0]
  v_pk_fma_f32 v[98:99], v[186:187], v[144:145], v[98:99] op_sel_hi:[1,0,1] neg_lo:[0,1,0] neg_hi:[0,1,0]
  v_pk_fma_f32 v[100:101], v[184:185], v[148:149], v[100:101] op_sel_hi:[1,0,1] neg_lo:[0,1,0] neg_hi:[0,1,0]
  v_pk_fma_f32 v[102:103], v[186:187], v[148:149], v[102:103] op_sel_hi:[1,0,1] neg_lo:[0,1,0] neg_hi:[0,1,0]
  v_pk_fma_f32 v[200:201], v[200:201], v[146:147], v[146:147] op_sel:[0,1,1] op_sel_hi:[1,1,1]
  v_pk_fma_f32 v[202:203], v[202:203], v[146:147], v[146:147] op_sel:[0,1,1] op_sel_hi:[1,1,1]
  v_pk_fma_f32 v[204:205], v[204:205], v[150:151], v[150:151] op_sel:[0,1,1] op_sel_hi:[1,1,1]
  v_pk_fma_f32 v[206:207], v[206:207], v[150:151], v[150:151] op_sel:[0,1,1] op_sel_hi:[1,1,1]
  v_pk_fma_f32 v[208:209], v[208:209], v[146:147], v[146:147] op_sel:[0,1,1] op_sel_hi:[1,1,1]
  v_pk_fma_f32 v[210:211], v[210:211], v[146:147], v[146:147] op_sel:[0,1,1] op_sel_hi:[1,1,1]
  v_pk_fma_f32 v[212:213], v[212:213], v[150:151], v[150:151] op_sel:[0,1,1] op_sel_hi:[1,1,1]
  v_pk_fma_f32 v[214:215], v[214:215], v[150:151], v[150:151] op_sel:[0,1,1] op_sel_hi:[1,1,1]
  v_pk_mul_f32 v[32:33], v[32:33], v[80:81]
  v_pk_mul_f32 v[34:35], v[34:35], v[82:83]
  v_pk_mul_f32 v[36:37], v[36:37], v[84:85]
  v_pk_mul_f32 v[38:39], v[38:39], v[86:87]
  v_pk_mul_f32 v[48:49], v[48:49], v[96:97]
  v_pk_mul_f32 v[50:51], v[50:51], v[98:99]
  v_pk_mul_f32 v[52:53], v[52:53], v[100:101]
  v_pk_mul_f32 v[54:55], v[54:55], v[102:103]
  v_rcp_f32 v200, v200
  v_rcp_f32 v201, v201
  v_rcp_f32 v202, v202
  v_rcp_f32 v203, v203
  v_rcp_f32 v204, v204
  v_rcp_f32 v205, v205
  v_rcp_f32 v206, v206
  v_rcp_f32 v207, v207
  v_rcp_f32 v208, v208
  v_rcp_f32 v209, v209
  v_rcp_f32 v210, v210
  v_rcp_f32 v211, v211
  v_rcp_f32 v212, v212
  v_rcp_f32 v213, v213
  v_rcp_f32 v214, v214
  v_rcp_f32 v215, v215
  v_pk_mul_f32 v[32:33], v[32:33], v[200:201]
  v_pk_mul_f32 v[34:35], v[34:35], v[202:203]
  v_pk_mul_f32 v[36:37], v[36:37], v[204:205]
  v_pk_mul_f32 v[38:39], v[38:39], v[206:207]
  v_pk_mul_f32 v[48:49], v[48:49], v[208:209]
  v_pk_mul_f32 v[50:51], v[50:51], v[210:211]
  v_pk_mul_f32 v[52:53], v[52:53], v[212:213]
  v_pk_mul_f32 v[54:55], v[54:55], v[214:215]
  v_cvt_pk_bf16_f32 v32, v32, v33
  v_cvt_pk_bf16_f32 v33, v34, v35
  ds_write_b64 v236, v[32:33] offset:0
  v_cvt_pk_bf16_f32 v36, v36, v37
  v_cvt_pk_bf16_f32 v37, v38, v39
  ds_write_b64 v236, v[36:37] offset:3840
  v_cvt_pk_bf16_f32 v48, v48, v49
  v_cvt_pk_bf16_f32 v49, v50, v51
  ds_write_b64 v236, v[48:49] offset:32
  v_cvt_pk_bf16_f32 v52, v52, v53
  v_cvt_pk_bf16_f32 v53, v54, v55
  ds_write_b64 v236, v[52:53] offset:3872
  v_pk_fma_f32 v[64:65], v[176:177], v[144:145], v[64:65] op_sel_hi:[1,0,1] neg_lo:[0,1,0] neg_hi:[0,1,0]
  v_pk_fma_f32 v[66:67], v[178:179], v[144:145], v[66:67] op_sel_hi:[1,0,1] neg_lo:[0,1,0] neg_hi:[0,1,0]
  v_pk_fma_f32 v[68:69], v[176:177], v[148:149], v[68:69] op_sel_hi:[1,0,1] neg_lo:[0,1,0] neg_hi:[0,1,0]
  v_pk_fma_f32 v[70:71], v[178:179], v[148:149], v[70:71] op_sel_hi:[1,0,1] neg_lo:[0,1,0] neg_hi:[0,1,0]
  v_pk_fma_f32 v[128:129], v[192:193], v[160:161], v[128:129] op_sel_hi:[1,0,1] neg_lo:[0,1,0] neg_hi:[0,1,0]
  v_pk_fma_f32 v[130:131], v[194:195], v[160:161], v[130:131] op_sel_hi:[1,0,1] neg_lo:[0,1,0] neg_hi:[0,1,0]
  v_pk_mul_f32 v[200:201], v[64:65], v[64:65]
  v_pk_mul_f32 v[202:203], v[66:67], v[66:67]
  v_pk_mul_f32 v[204:205], v[68:69], v[68:69]
  v_pk_mul_f32 v[206:207], v[70:71], v[70:71]
  v_pk_mul_f32 v[208:209], v[128:129], v[128:129]
  v_pk_mul_f32 v[210:211], v[130:131], v[130:131]
  v_pk_fma_f32 v[200:201], v[200:201], v[146:147], v[144:145] op_sel:[0,0,1] op_sel_hi:[1,0,1]
  v_pk_fma_f32 v[202:203], v[202:203], v[146:147], v[144:145] op_sel:[0,0,1] op_sel_hi:[1,0,1]
  v_pk_fma_f32 v[204:205], v[204:205], v[150:151], v[148:149] op_sel:[0,0,1] op_sel_hi:[1,0,1]
  v_pk_fma_f32 v[206:207], v[206:207], v[150:151], v[148:149] op_sel:[0,0,1] op_sel_hi:[1,0,1]
  v_pk_fma_f32 v[208:209], v[208:209], v[162:163], v[160:161] op_sel:[0,0,1] op_sel_hi:[1,0,1]
  v_pk_fma_f32 v[210:211], v[210:211], v[162:163], v[160:161] op_sel:[0,0,1] op_sel_hi:[1,0,1]
  v_pk_mul_f32 v[200:201], v[200:201], v[64:65]
  v_pk_mul_f32 v[202:203], v[202:203], v[66:67]
  v_pk_mul_f32 v[204:205], v[204:205], v[68:69]
  v_pk_mul_f32 v[206:207], v[206:207], v[70:71]
  v_pk_mul_f32 v[208:209], v[208:209], v[128:129]
  v_pk_mul_f32 v[210:211], v[210:211], v[130:131]
  v_exp_f32 v200, v200
  v_exp_f32 v201, v201
  v_exp_f32 v202, v202
  v_exp_f32 v203, v203
  v_exp_f32 v204, v204
  v_exp_f32 v205, v205
  v_exp_f32 v206, v206
  v_exp_f32 v207, v207
  v_exp_f32 v208, v208
  v_exp_f32 v209, v209
  v_exp_f32 v210, v210
  v_exp_f32 v211, v211
  v_pk_fma_f32 v[112:113], v[188:189], v[144:145], v[112:113] op_sel_hi:[1,0,1] neg_lo:[0,1,0] neg_hi:[0,1,0]
  v_pk_fma_f32 v[114:115], v[190:191], v[144:145], v[114:115] op_sel_hi:[1,0,1] neg_lo:[0,1,0] neg_hi:[0,1,0]
  v_pk_fma_f32 v[116:117], v[188:189], v[148:149], v[116:117] op_sel_hi:[1,0,1] neg_lo:[0,1,0] neg_hi:[0,1,0]
  v_pk_fma_f32 v[118:119], v[190:191], v[148:149], v[118:119] op_sel_hi:[1,0,1] neg_lo:[0,1,0] neg_hi:[0,1,0]
  v_pk_fma_f32 v[132:133], v[196:197], v[160:161], v[132:133] op_sel_hi:[1,0,1] neg_lo:[0,1,0] neg_hi:[0,1,0]
  v_pk_fma_f32 v[134:135], v[198:199], v[160:161], v[134:135] op_sel_hi:[1,0,1] neg_lo:[0,1,0] neg_hi:[0,1,0]
  v_pk_fma_f32 v[200:201], v[200:201], v[146:147], v[146:147] op_sel:[0,1,1] op_sel_hi:[1,1,1]
  v_pk_fma_f32 v[202:203], v[202:203], v[146:147], v[146:147] op_sel:[0,1,1] op_sel_hi:[1,1,1]
  v_pk_fma_f32 v[204:205], v[204:205], v[150:151], v[150:151] op_sel:[0,1,1] op_sel_hi:[1,1,1]
  v_pk_fma_f32 v[206:207], v[206:207], v[150:151], v[150:151] op_sel:[0,1,1] op_sel_hi:[1,1,1]
  v_pk_fma_f32 v[208:209], v[208:209], v[162:163], v[162:163] op_sel:[0,1,1] op_sel_hi:[1,1,1]
  v_pk_fma_f32 v[210:211], v[210:211], v[162:163], v[162:163] op_sel:[0,1,1] op_sel_hi:[1,1,1]
  v_pk_mul_f32 v[64:65], v[64:65], v[112:113]
  v_pk_mul_f32 v[66:67], v[66:67], v[114:115]
  v_pk_mul_f32 v[68:69], v[68:69], v[116:117]
  v_pk_mul_f32 v[70:71], v[70:71], v[118:119]
  v_pk_mul_f32 v[128:129], v[128:129], v[132:133]
  v_pk_mul_f32 v[130:131], v[130:131], v[134:135]
  v_rcp_f32 v200, v200
  v_rcp_f32 v201, v201
  v_rcp_f32 v202, v202
  v_rcp_f32 v203, v203
  v_rcp_f32 v204, v204
  v_rcp_f32 v205, v205
  v_rcp_f32 v206, v206
  v_rcp_f32 v207, v207
  v_rcp_f32 v208, v208
  v_rcp_f32 v209, v209
  v_rcp_f32 v210, v210
  v_rcp_f32 v211, v211
  v_pk_mul_f32 v[64:65], v[64:65], v[200:201]
  v_pk_mul_f32 v[66:67], v[66:67], v[202:203]
  v_pk_mul_f32 v[68:69], v[68:69], v[204:205]
  v_pk_mul_f32 v[70:71], v[70:71], v[206:207]
  v_pk_mul_f32 v[128:129], v[128:129], v[208:209]
  v_pk_mul_f32 v[130:131], v[130:131], v[210:211]
  v_cvt_pk_bf16_f32 v64, v64, v65
  v_cvt_pk_bf16_f32 v65, v66, v67
  ds_write_b64 v236, v[64:65] offset:64
  v_cvt_pk_bf16_f32 v68, v68, v69
  v_cvt_pk_bf16_f32 v69, v70, v71
  ds_write_b64 v236, v[68:69] offset:3904
  v_cvt_pk_bf16_f32 v128, v128, v129
  v_cvt_pk_bf16_f32 v129, v130, v131
  ds_write_b64 v237, v[128:129] offset:0
  s_waitcnt lgkmcnt(0)
  s_barrier
  v_pk_fma_f32 v[40:41], v[168:169], v[152:153], v[40:41] op_sel_hi:[1,0,1] neg_lo:[0,1,0] neg_hi:[0,1,0]
  v_pk_fma_f32 v[42:43], v[170:171], v[152:153], v[42:43] op_sel_hi:[1,0,1] neg_lo:[0,1,0] neg_hi:[0,1,0]
  v_pk_fma_f32 v[44:45], v[168:169], v[156:157], v[44:45] op_sel_hi:[1,0,1] neg_lo:[0,1,0] neg_hi:[0,1,0]
  v_pk_fma_f32 v[46:47], v[170:171], v[156:157], v[46:47] op_sel_hi:[1,0,1] neg_lo:[0,1,0] neg_hi:[0,1,0]
  v_pk_fma_f32 v[56:57], v[172:173], v[152:153], v[56:57] op_sel_hi:[1,0,1] neg_lo:[0,1,0] neg_hi:[0,1,0]
  v_pk_fma_f32 v[58:59], v[174:175], v[152:153], v[58:59] op_sel_hi:[1,0,1] neg_lo:[0,1,0] neg_hi:[0,1,0]
  v_pk_fma_f32 v[60:61], v[172:173], v[156:157], v[60:61] op_sel_hi:[1,0,1] neg_lo:[0,1,0] neg_hi:[0,1,0]
  v_pk_fma_f32 v[62:63], v[174:175], v[156:157], v[62:63] op_sel_hi:[1,0,1] neg_lo:[0,1,0] neg_hi:[0,1,0]
  v_pk_mul_f32 v[200:201], v[40:41], v[40:41]
  v_pk_mul_f32 v[202:203], v[42:43], v[42:43]
  v_pk_mul_f32 v[204:205], v[44:45], v[44:45]
  v_pk_mul_f32 v[206:207], v[46:47], v[46:47]
  v_pk_mul_f32 v[208:209], v[56:57], v[56:57]
  v_pk_mul_f32 v[210:211], v[58:59], v[58:59]
  v_pk_mul_f32 v[212:213], v[60:61], v[60:61]
  v_pk_mul_f32 v[214:215], v[62:63], v[62:63]
  v_pk_fma_f32 v[200:201], v[200:201], v[154:155], v[152:153] op_sel:[0,0,1] op_sel_hi:[1,0,1]
  v_pk_fma_f32 v[202:203], v[202:203], v[154:155], v[152:153] op_sel:[0,0,1] op_sel_hi:[1,0,1]
  v_pk_fma_f32 v[204:205], v[204:205], v[158:159], v[156:157] op_sel:[0,0,1] op_sel_hi:[1,0,1]
  v_pk_fma_f32 v[206:207], v[206:207], v[158:159], v[156:157] op_sel:[0,0,1] op_sel_hi:[1,0,1]
  v_pk_fma_f32 v[208:209], v[208:209], v[154:155], v[152:153] op_sel:[0,0,1] op_sel_hi:[1,0,1]
  v_pk_fma_f32 v[210:211], v[210:211], v[154:155], v[152:153] op_sel:[0,0,1] op_sel_hi:[1,0,1]
  v_pk_fma_f32 v[212:213], v[212:213], v[158:159], v[156:157] op_sel:[0,0,1] op_sel_hi:[1,0,1]
  v_pk_fma_f32 v[214:215], v[214:215], v[158:159], v[156:157] op_sel:[0,0,1] op_sel_hi:[1,0,1]
  v_pk_mul_f32 v[200:201], v[200:201], v[40:41]
  v_pk_mul_f32 v[202:203], v[202:203], v[42:43]
  v_pk_mul_f32 v[204:205], v[204:205], v[44:45]
  v_pk_mul_f32 v[206:207], v[206:207], v[46:47]
  v_pk_mul_f32 v[208:209], v[208:209], v[56:57]
  v_pk_mul_f32 v[210:211], v[210:211], v[58:59]
  v_pk_mul_f32 v[212:213], v[212:213], v[60:61]
  v_pk_mul_f32 v[214:215], v[214:215], v[62:63]
  v_exp_f32 v200, v200
  v_exp_f32 v201, v201
  v_exp_f32 v202, v202
  v_exp_f32 v203, v203
  v_exp_f32 v204, v204
  v_exp_f32 v205, v205
  v_exp_f32 v206, v206
  v_exp_f32 v207, v207
  v_exp_f32 v208, v208
  v_exp_f32 v209, v209
  v_exp_f32 v210, v210
  v_exp_f32 v211, v211
  v_exp_f32 v212, v212
  v_exp_f32 v213, v213
  v_exp_f32 v214, v214
  v_exp_f32 v215, v215
  v_pk_fma_f32 v[88:89], v[180:181], v[152:153], v[88:89] op_sel_hi:[1,0,1] neg_lo:[0,1,0] neg_hi:[0,1,0]
  v_pk_fma_f32 v[90:91], v[182:183], v[152:153], v[90:91] op_sel_hi:[1,0,1] neg_lo:[0,1,0] neg_hi:[0,1,0]
  v_pk_fma_f32 v[92:93], v[180:181], v[156:157], v[92:93] op_sel_hi:[1,0,1] neg_lo:[0,1,0] neg_hi:[0,1,0]
  v_pk_fma_f32 v[94:95], v[182:183], v[156:157], v[94:95] op_sel_hi:[1,0,1] neg_lo:[0,1,0] neg_hi:[0,1,0]
  v_pk_fma_f32 v[104:105], v[184:185], v[152:153], v[104:105] op_sel_hi:[1,0,1] neg_lo:[0,1,0] neg_hi:[0,1,0]
  v_pk_fma_f32 v[106:107], v[186:187], v[152:153], v[106:107] op_sel_hi:[1,0,1] neg_lo:[0,1,0] neg_hi:[0,1,0]
  v_pk_fma_f32 v[108:109], v[184:185], v[156:157], v[108:109] op_sel_hi:[1,0,1] neg_lo:[0,1,0] neg_hi:[0,1,0]
  v_pk_fma_f32 v[110:111], v[186:187], v[156:157], v[110:111] op_sel_hi:[1,0,1] neg_lo:[0,1,0] neg_hi:[0,1,0]
  v_pk_fma_f32 v[200:201], v[200:201], v[154:155], v[154:155] op_sel:[0,1,1] op_sel_hi:[1,1,1]
  v_pk_fma_f32 v[202:203], v[202:203], v[154:155], v[154:155] op_sel:[0,1,1] op_sel_hi:[1,1,1]
  v_pk_fma_f32 v[204:205], v[204:205], v[158:159], v[158:159] op_sel:[0,1,1] op_sel_hi:[1,1,1]
  v_pk_fma_f32 v[206:207], v[206:207], v[158:159], v[158:159] op_sel:[0,1,1] op_sel_hi:[1,1,1]
  v_pk_fma_f32 v[208:209], v[208:209], v[154:155], v[154:155] op_sel:[0,1,1] op_sel_hi:[1,1,1]
  v_pk_fma_f32 v[210:211], v[210:211], v[154:155], v[154:155] op_sel:[0,1,1] op_sel_hi:[1,1,1]
  v_pk_fma_f32 v[212:213], v[212:213], v[158:159], v[158:159] op_sel:[0,1,1] op_sel_hi:[1,1,1]
  v_pk_fma_f32 v[214:215], v[214:215], v[158:159], v[158:159] op_sel:[0,1,1] op_sel_hi:[1,1,1]
  v_pk_mul_f32 v[40:41], v[40:41], v[88:89]
  v_pk_mul_f32 v[42:43], v[42:43], v[90:91]
  v_pk_mul_f32 v[44:45], v[44:45], v[92:93]
  v_pk_mul_f32 v[46:47], v[46:47], v[94:95]
  v_pk_mul_f32 v[56:57], v[56:57], v[104:105]
  v_pk_mul_f32 v[58:59], v[58:59], v[106:107]
  v_pk_mul_f32 v[60:61], v[60:61], v[108:109]
  v_pk_mul_f32 v[62:63], v[62:63], v[110:111]
  v_rcp_f32 v200, v200
  v_rcp_f32 v201, v201
  v_rcp_f32 v202, v202
  v_rcp_f32 v203, v203
  v_rcp_f32 v204, v204
  v_rcp_f32 v205, v205
  v_rcp_f32 v206, v206
  v_rcp_f32 v207, v207
  v_rcp_f32 v208, v208
  v_rcp_f32 v209, v209
  v_rcp_f32 v210, v210
  v_rcp_f32 v211, v211
  v_rcp_f32 v212, v212
  v_rcp_f32 v213, v213
  v_rcp_f32 v214, v214
  v_rcp_f32 v215, v215
  v_pk_mul_f32 v[40:41], v[40:41], v[200:201]
  v_pk_mul_f32 v[42:43], v[42:43], v[202:203]
  v_pk_mul_f32 v[44:45], v[44:45], v[204:205]
  v_pk_mul_f32 v[46:47], v[46:47], v[206:207]
  v_pk_mul_f32 v[56:57], v[56:57], v[208:209]
  v_pk_mul_f32 v[58:59], v[58:59], v[210:211]
  v_pk_mul_f32 v[60:61], v[60:61], v[212:213]
  v_pk_mul_f32 v[62:63], v[62:63], v[214:215]
  v_cvt_pk_bf16_f32 v40, v40, v41
  v_cvt_pk_bf16_f32 v41, v42, v43
  ds_write_b64 v236, v[40:41] offset:7680
  v_cvt_pk_bf16_f32 v44, v44, v45
  v_cvt_pk_bf16_f32 v45, v46, v47
  ds_write_b64 v236, v[44:45] offset:11520
  v_cvt_pk_bf16_f32 v56, v56, v57
  v_cvt_pk_bf16_f32 v57, v58, v59
  ds_write_b64 v236, v[56:57] offset:7712
  v_cvt_pk_bf16_f32 v60, v60, v61
  v_cvt_pk_bf16_f32 v61, v62, v63
  ds_write_b64 v236, v[60:61] offset:11552
  v_pk_fma_f32 v[72:73], v[176:177], v[152:153], v[72:73] op_sel_hi:[1,0,1] neg_lo:[0,1,0] neg_hi:[0,1,0]
  v_pk_fma_f32 v[74:75], v[178:179], v[152:153], v[74:75] op_sel_hi:[1,0,1] neg_lo:[0,1,0] neg_hi:[0,1,0]
  v_pk_fma_f32 v[76:77], v[176:177], v[156:157], v[76:77] op_sel_hi:[1,0,1] neg_lo:[0,1,0] neg_hi:[0,1,0]
  v_pk_fma_f32 v[78:79], v[178:179], v[156:157], v[78:79] op_sel_hi:[1,0,1] neg_lo:[0,1,0] neg_hi:[0,1,0]
  v_pk_fma_f32 v[136:137], v[192:193], v[164:165], v[136:137] op_sel_hi:[1,0,1] neg_lo:[0,1,0] neg_hi:[0,1,0]
  v_pk_fma_f32 v[138:139], v[194:195], v[164:165], v[138:139] op_sel_hi:[1,0,1] neg_lo:[0,1,0] neg_hi:[0,1,0]
  v_pk_mul_f32 v[200:201], v[72:73], v[72:73]
  v_pk_mul_f32 v[202:203], v[74:75], v[74:75]
  v_pk_mul_f32 v[204:205], v[76:77], v[76:77]
  v_pk_mul_f32 v[206:207], v[78:79], v[78:79]
  v_pk_mul_f32 v[208:209], v[136:137], v[136:137]
  v_pk_mul_f32 v[210:211], v[138:139], v[138:139]
  v_pk_fma_f32 v[200:201], v[200:201], v[154:155], v[152:153] op_sel:[0,0,1] op_sel_hi:[1,0,1]
  v_pk_fma_f32 v[202:203], v[202:203], v[154:155], v[152:153] op_sel:[0,0,1] op_sel_hi:[1,0,1]
  v_pk_fma_f32 v[204:205], v[204:205], v[158:159], v[156:157] op_sel:[0,0,1] op_sel_hi:[1,0,1]
  v_pk_fma_f32 v[206:207], v[206:207], v[158:159], v[156:157] op_sel:[0,0,1] op_sel_hi:[1,0,1]
  v_pk_fma_f32 v[208:209], v[208:209], v[166:167], v[164:165] op_sel:[0,0,1] op_sel_hi:[1,0,1]
  v_pk_fma_f32 v[210:211], v[210:211], v[166:167], v[164:165] op_sel:[0,0,1] op_sel_hi:[1,0,1]
  v_pk_mul_f32 v[200:201], v[200:201], v[72:73]
  v_pk_mul_f32 v[202:203], v[202:203], v[74:75]
  v_pk_mul_f32 v[204:205], v[204:205], v[76:77]
  v_pk_mul_f32 v[206:207], v[206:207], v[78:79]
  v_pk_mul_f32 v[208:209], v[208:209], v[136:137]
  v_pk_mul_f32 v[210:211], v[210:211], v[138:139]
  v_exp_f32 v200, v200
  v_exp_f32 v201, v201
  v_exp_f32 v202, v202
  v_exp_f32 v203, v203
  v_exp_f32 v204, v204
  v_exp_f32 v205, v205
  v_exp_f32 v206, v206
  v_exp_f32 v207, v207
  v_exp_f32 v208, v208
  v_exp_f32 v209, v209
  v_exp_f32 v210, v210
  v_exp_f32 v211, v211
  v_pk_fma_f32 v[120:121], v[188:189], v[152:153], v[120:121] op_sel_hi:[1,0,1] neg_lo:[0,1,0] neg_hi:[0,1,0]
  v_pk_fma_f32 v[122:123], v[190:191], v[152:153], v[122:123] op_sel_hi:[1,0,1] neg_lo:[0,1,0] neg_hi:[0,1,0]
  v_pk_fma_f32 v[124:125], v[188:189], v[156:157], v[124:125] op_sel_hi:[1,0,1] neg_lo:[0,1,0] neg_hi:[0,1,0]
  v_pk_fma_f32 v[126:127], v[190:191], v[156:157], v[126:127] op_sel_hi:[1,0,1] neg_lo:[0,1,0] neg_hi:[0,1,0]
  v_pk_fma_f32 v[140:141], v[196:197], v[164:165], v[140:141] op_sel_hi:[1,0,1] neg_lo:[0,1,0] neg_hi:[0,1,0]
  v_pk_fma_f32 v[142:143], v[198:199], v[164:165], v[142:143] op_sel_hi:[1,0,1] neg_lo:[0,1,0] neg_hi:[0,1,0]
  v_pk_fma_f32 v[200:201], v[200:201], v[154:155], v[154:155] op_sel:[0,1,1] op_sel_hi:[1,1,1]
  v_pk_fma_f32 v[202:203], v[202:203], v[154:155], v[154:155] op_sel:[0,1,1] op_sel_hi:[1,1,1]
  v_pk_fma_f32 v[204:205], v[204:205], v[158:159], v[158:159] op_sel:[0,1,1] op_sel_hi:[1,1,1]
  v_pk_fma_f32 v[206:207], v[206:207], v[158:159], v[158:159] op_sel:[0,1,1] op_sel_hi:[1,1,1]
  v_pk_fma_f32 v[208:209], v[208:209], v[166:167], v[166:167] op_sel:[0,1,1] op_sel_hi:[1,1,1]
  v_pk_fma_f32 v[210:211], v[210:211], v[166:167], v[166:167] op_sel:[0,1,1] op_sel_hi:[1,1,1]
  v_pk_mul_f32 v[72:73], v[72:73], v[120:121]
  v_pk_mul_f32 v[74:75], v[74:75], v[122:123]
  v_pk_mul_f32 v[76:77], v[76:77], v[124:125]
  v_pk_mul_f32 v[78:79], v[78:79], v[126:127]
  v_pk_mul_f32 v[136:137], v[136:137], v[140:141]
  v_pk_mul_f32 v[138:139], v[138:139], v[142:143]
  v_rcp_f32 v200, v200
  v_rcp_f32 v201, v201
  v_rcp_f32 v202, v202
  v_rcp_f32 v203, v203
  v_rcp_f32 v204, v204
  v_rcp_f32 v205, v205
  v_rcp_f32 v206, v206
  v_rcp_f32 v207, v207
  v_rcp_f32 v208, v208
  v_rcp_f32 v209, v209
  v_rcp_f32 v210, v210
  v_rcp_f32 v211, v211
  v_pk_mul_f32 v[72:73], v[72:73], v[200:201]
  v_pk_mul_f32 v[74:75], v[74:75], v[202:203]
  v_pk_mul_f32 v[76:77], v[76:77], v[204:205]
  v_pk_mul_f32 v[78:79], v[78:79], v[206:207]
  v_pk_mul_f32 v[136:137], v[136:137], v[208:209]
  v_pk_mul_f32 v[138:139], v[138:139], v[210:211]
  v_cvt_pk_bf16_f32 v72, v72, v73
  v_cvt_pk_bf16_f32 v73, v74, v75
  ds_write_b64 v236, v[72:73] offset:7744
  v_cvt_pk_bf16_f32 v76, v76, v77
  v_cvt_pk_bf16_f32 v77, v78, v79
  ds_write_b64 v236, v[76:77] offset:11584
  v_cvt_pk_bf16_f32 v136, v136, v137
  v_cvt_pk_bf16_f32 v137, v138, v139
  ds_write_b64 v237, v[136:137] offset:7680
  s_branch Ljoin_49
Lprod_48:
  s_sub_u32 s53, s48, 4
  s_add_u32 s32, s26, 19922944
  s_addc_u32 s33, s27, 0
  s_mov_b32 s34, 4194304
  s_mov_b32 s35, 0x20000
  v_lshlrev_b32 v11, 4, v1
  s_lshl_b32 s63, s53, 13
  v_add_u32 v11, s63, v11
  v_add_u32 v12, 4096, v11
  s_lshl_b32 s62, s1, 18
  s_and_b32 s58, s0, 1
  s_lshl_b32 s58, s58, 2
  s_waitcnt vmcnt(0)
  s_barrier
  s_cmp_eq_u32 s48, 0
  s_cbranch_scc0 Lsig_57
  s_lshl_b32 s54, s14, 7
  s_add_u32 s54, s54, 98304
  v_mov_b32 v2, s4
  v_mov_b32 v3, 0
  s_mov_b64 exec, 1
  buffer_store_dword v2, v3, s[44:47], s54 offen sc1
  s_mov_b64 exec, -1
Lsig_57:
  s_add_u32 s36, s26, 10485760
  s_addc_u32 s37, s27, 0
  s_mov_b32 s38, 524288
  s_mov_b32 s39, 0x20000
  v_subrev_u32 v9, 256, v0
  v_cmp_le_u32 vcc, 112, v9
  v_mov_b32 v3, 0
  v_mov_b32 v4, 1680
  v_cndmask_b32 v3, v3, v4, vcc
  v_add_u32 v3, v3, v9
  v_min_u32 v3, 3583, v3
  v_lshlrev_b32 v3, 2, v3
  s_mul_i32 s54, s1, 448
  s_add_u32 s54, s54, 262144
  buffer_load_dword v32, v3, s[36:39], s54 offen sc1
  s_add_u32 s54, s54, 14336
  buffer_load_dword v33, v3, s[36:39], s54 offen sc1
  s_add_u32 s54, s54, 14336
  buffer_load_dword v34, v3, s[36:39], s54 offen sc1
  s_add_u32 s54, s54, 14336
  buffer_load_dword v35, v3, s[36:39], s54 offen sc1
  s_add_u32 s54, s54, 14336
  buffer_load_dword v36, v3, s[36:39], s54 offen sc1
  s_add_u32 s54, s54, 14336
  buffer_load_dword v37, v3, s[36:39], s54 offen sc1
  s_add_u32 s54, s54, 14336
  buffer_load_dword v38, v3, s[36:39], s54 offen sc1
  s_add_u32 s54, s54, 14336
  buffer_load_dword v39, v3, s[36:39], s54 offen sc1
  s_add_u32 s54, s54, 14336
  s_add_u32 s62, s62, 32768
  s_add_u32 m0, s63, 49152
  s_nop 0
  buffer_load_dwordx4 v11, s[32:35], s62 offen sc1 lds
  buffer_load_dwordx4 v11, s[32:35], s62 offen offset:1024 sc1 lds
  buffer_load_dwordx4 v11, s[32:35], s62 offen offset:2048 sc1 lds
  buffer_load_dwordx4 v11, s[32:35], s62 offen offset:3072 sc1 lds
  s_add_u32 m0, s63, 53248
  s_nop 0
  buffer_load_dwordx4 v12, s[32:35], s62 offen sc1 lds
  buffer_load_dwordx4 v12, s[32:35], s62 offen offset:1024 sc1 lds
  buffer_load_dwordx4 v12, s[32:35], s62 offen offset:2048 sc1 lds
  buffer_load_dwordx4 v12, s[32:35], s62 offen offset:3072 sc1 lds
  s_add_u32 s62, s62, 32768
  v_lshrrev_b32 v2, 3, v1
  v_and_b32 v3, 7, v1
  v_xor_b32 v3, v2, v3
  v_lshlrev_b32 v3, 4, v3
  v_lshl_add_u32 v3, v2, 7, v3
  s_lshr_b32 s54, s53, 1
  s_lshl_b32 s54, s54, 16
  s_and_b32 s55, s53, 1
  s_lshl_b32 s55, s55, 12
  s_add_u32 s54, s54, s55
  v_add_u32 v10, s54, v3
  s_add_u32 s28, s26, 8388608
  s_addc_u32 s29, s27, 0
  s_mov_b32 s30, 2097152
  s_mov_b32 s31, 0x20000
  s_lshl_b32 s61, s0, 17
  s_lshl_b32 s59, s53, 12
  s_waitcnt vmcnt(8)
  v_add_f32 v32, v32, v33
  v_add_f32 v34, v34, v35
  v_add_f32 v36, v36, v37
  v_add_f32 v38, v38, v39
  v_add_f32 v32, v32, v34
  v_add_f32 v36, v36, v38
  v_add_f32 v32, v32, v36
  v_lshlrev_b32 v4, 2, v9
  v_add_u32 v4, 114688, v4
  ds_write_b32 v4, v32
  v_and_b32 v4, 31, v1
  s_lshl_b32 s54, s0, 7
  s_lshl_b32 s55, s53, 5
  s_add_u32 s54, s54, s55
  v_add_u32 v5, s54, v4
  v_lshlrev_b32 v5, 6, v5
  v_lshrrev_b32 v6, 5, v1
  v_lshl_add_u32 v5, v6, 5, v5
  s_barrier
  s_add_u32 m0, s59, 0
  s_nop 0
  buffer_load_dwordx4 v10, s[28:31], s61 offen sc1 lds
  buffer_load_dwordx4 v10, s[28:31], s61 offen offset:1024 sc1 lds
  buffer_load_dwordx4 v10, s[28:31], s61 offen offset:2048 sc1 lds
  buffer_load_dwordx4 v10, s[28:31], s61 offen offset:3072 sc1 lds
  s_add_u32 s61, s61, 8192
  s_add_u32 m0, s59, 16384
  s_nop 0
  buffer_load_dwordx4 v10, s[28:31], s61 offen sc1 lds
  buffer_load_dwordx4 v10, s[28:31], s61 offen offset:1024 sc1 lds
  buffer_load_dwordx4 v10, s[28:31], s61 offen offset:2048 sc1 lds
  buffer_load_dwordx4 v10, s[28:31], s61 offen offset:3072 sc1 lds
  s_add_u32 s61, s61, 8192
  s_waitcnt vmcnt(4)
  s_barrier
  s_add_u32 m0, s63, 81920
  s_nop 0
  buffer_load_dwordx4 v11, s[32:35], s62 offen sc1 lds
  buffer_load_dwordx4 v11, s[32:35], s62 offen offset:1024 sc1 lds
  buffer_load_dwordx4 v11, s[32:35], s62 offen offset:2048 sc1 lds
  buffer_load_dwordx4 v11, s[32:35], s62 offen offset:3072 sc1 lds
  s_add_u32 m0, s63, 86016
  s_nop 0
  buffer_load_dwordx4 v12, s[32:35], s62 offen sc1 lds
  buffer_load_dwordx4 v12, s[32:35], s62 offen offset:1024 sc1 lds
  buffer_load_dwordx4 v12, s[32:35], s62 offen offset:2048 sc1 lds
  buffer_load_dwordx4 v12, s[32:35], s62 offen offset:3072 sc1 lds
  s_add_u32 s62, s62, 32768
  s_add_u32 m0, s59, 32768
  s_nop 0
  buffer_load_dwordx4 v10, s[28:31], s61 offen sc1 lds
  buffer_load_dwordx4 v10, s[28:31], s61 offen offset:1024 sc1 lds
  buffer_load_dwordx4 v10, s[28:31], s61 offen offset:2048 sc1 lds
  buffer_load_dwordx4 v10, s[28:31], s61 offen offset:3072 sc1 lds
  s_add_u32 s61, s61, 8192
  buffer_load_dwordx4 v[40:43], v5, s[36:39], 0 offen sc1
  buffer_load_dwordx4 v[44:47], v5, s[36:39], 0 offen offset:16 sc1
  s_waitcnt vmcnt(14)
  s_barrier
  s_add_u32 m0, s59, 0
  s_nop 0
  buffer_load_dwordx4 v10, s[28:31], s61 offen sc1 lds
  buffer_load_dwordx4 v10, s[28:31], s61 offen offset:1024 sc1 lds
  buffer_load_dwordx4 v10, s[28:31], s61 offen offset:2048 sc1 lds
  buffer_load_dwordx4 v10, s[28:31], s61 offen offset:3072 sc1 lds
  s_add_u32 s61, s61, 8192
  s_add_u32 m0, s63, 131072
  s_nop 0
  buffer_load_dwordx4 v11, s[32:35], s62 offen sc1 lds
  buffer_load_dwordx4 v11, s[32:35], s62 offen offset:1024 sc1 lds
  buffer_load_dwordx4 v11, s[32:35], s62 offen offset:2048 sc1 lds
  buffer_load_dwordx4 v11, s[32:35], s62 offen offset:3072 sc1 lds
  s_add_u32 m0, s63, 135168
  s_nop 0
  buffer_load_dwordx4 v12, s[32:35], s62 offen sc1 lds
  buffer_load_dwordx4 v12, s[32:35], s62 offen offset:1024 sc1 lds
  buffer_load_dwordx4 v12, s[32:35], s62 offen offset:2048 sc1 lds
  buffer_load_dwordx4 v12, s[32:35], s62 offen offset:3072 sc1 lds
  s_add_u32 s62, s62, 32768
  s_waitcnt vmcnt(14)
  s_barrier
  s_add_u32 m0, s59, 16384
  s_nop 0
  buffer_load_dwordx4 v10, s[28:31], s61 offen sc1 lds
  buffer_load_dwordx4 v10, s[28:31], s61 offen offset:1024 sc1 lds
  buffer_load_dwordx4 v10, s[28:31], s61 offen offset:2048 sc1 lds
  buffer_load_dwordx4 v10, s[28:31], s61 offen offset:3072 sc1 lds
  s_add_u32 s61, s61, 8192
  s_add_u32 m0, s63, 49152
  s_nop 0
  buffer_load_dwordx4 v11, s[32:35], s62 offen sc1 lds
  buffer_load_dwordx4 v11, s[32:35], s62 offen offset:1024 sc1 lds
  buffer_load_dwordx4 v11, s[32:35], s62 offen offset:2048 sc1 lds
  buffer_load_dwordx4 v11, s[32:35], s62 offen offset:3072 sc1 lds
  s_add_u32 m0, s63, 53248
  s_nop 0
  buffer_load_dwordx4 v12, s[32:35], s62 offen sc1 lds
  buffer_load_dwordx4 v12, s[32:35], s62 offen offset:1024 sc1 lds
  buffer_load_dwordx4 v12, s[32:35], s62 offen offset:2048 sc1 lds
  buffer_load_dwordx4 v12, s[32:35], s62 offen offset:3072 sc1 lds
  s_add_u32 s62, s62, 32768
  s_waitcnt vmcnt(12)
  s_barrier
  s_add_u32 m0, s59, 32768
  s_nop 0
  buffer_load_dwordx4 v10, s[28:31], s61 offen sc1 lds
  buffer_load_dwordx4 v10, s[28:31], s61 offen offset:1024 sc1 lds
  buffer_load_dwordx4 v10, s[28:31], s61 offen offset:2048 sc1 lds
  buffer_load_dwordx4 v10, s[28:31], s61 offen offset:3072 sc1 lds
  s_add_u32 s61, s61, 8192
  s_add_u32 m0, s63, 81920
  s_nop 0
  buffer_load_dwordx4 v11, s[32:35], s62 offen sc1 lds
  buffer_load_dwordx4 v11, s[32:35], s62 offen offset:1024 sc1 lds
  buffer_load_dwordx4 v11, s[32:35], s62 offen offset:2048 sc1 lds
  buffer_load_dwordx4 v11, s[32:35], s62 offen offset:3072 sc1 lds
  s_add_u32 m0, s63, 86016
  s_nop 0
  buffer_load_dwordx4 v12, s[32:35], s62 offen sc1 lds
  buffer_load_dwordx4 v12, s[32:35], s62 offen offset:1024 sc1 lds
  buffer_load_dwordx4 v12, s[32:35], s62 offen offset:2048 sc1 lds
  buffer_load_dwordx4 v12, s[32:35], s62 offen offset:3072 sc1 lds
  s_add_u32 s62, s62, 32768
  v_add_f32 v40, v40, v42
  v_add_f32 v41, v41, v43
  v_add_f32 v44, v44, v46
  v_add_f32 v45, v45, v47
  v_add_f32 v40, v40, v44
  v_add_f32 v41, v41, v45
  v_mov_b32 v42, v40
  v_mov_b32 v43, v41
  s_nop 0
  v_permlane32_swap_b32 v40, v42
  v_permlane32_swap_b32 v41, v43
  v_add_f32 v40, v40, v42
  v_add_f32 v41, v41, v43
  v_mul_f32 v48, 0x3b000000, v40
  v_mul_f32 v42, v48, v48
  v_mov_b32 v43, 0x3b000000
  v_fma_f32 v42, v41, v43, -v42
  v_max_f32 v42, 0, v42
  v_add_f32 v51, 0x3727c5ac, v42
  v_rsq_f32 v43, v51
  s_nop 0
  v_mul_f32 v49, 0xc0135761, v43
  v_mul_f32 v42, v43, v43
  v_mul_f32 v42, v42, v43
  v_mul_f32 v50, 0xbdd2d3e8, v42
  s_lshl_b32 s54, s53, 9
  s_add_u32 s54, s54, 115712
  v_lshl_add_u32 v4, v4, 4, s54
  ds_write_b128 v4, v[48:51]
  s_waitcnt lgkmcnt(0)
  s_waitcnt vmcnt(12)
  s_barrier
  s_add_u32 m0, s59, 0
  s_nop 0
  buffer_load_dwordx4 v10, s[28:31], s61 offen sc1 lds
  buffer_load_dwordx4 v10, s[28:31], s61 offen offset:1024 sc1 lds
  buffer_load_dwordx4 v10, s[28:31], s61 offen offset:2048 sc1 lds
  buffer_load_dwordx4 v10, s[28:31], s61 offen offset:3072 sc1 lds
  s_add_u32 s61, s61, 8192
  s_add_u32 m0, s63, 131072
  s_nop 0
  buffer_load_dwordx4 v11, s[32:35], s62 offen sc1 lds
  buffer_load_dwordx4 v11, s[32:35], s62 offen offset:1024 sc1 lds
  buffer_load_dwordx4 v11, s[32:35], s62 offen offset:2048 sc1 lds
  buffer_load_dwordx4 v11, s[32:35], s62 offen offset:3072 sc1 lds
  s_add_u32 m0, s63, 135168
  s_nop 0
  buffer_load_dwordx4 v12, s[32:35], s62 offen sc1 lds
  buffer_load_dwordx4 v12, s[32:35], s62 offen offset:1024 sc1 lds
  buffer_load_dwordx4 v12, s[32:35], s62 offen offset:2048 sc1 lds
  buffer_load_dwordx4 v12, s[32:35], s62 offen offset:3072 sc1 lds
  s_add_u32 s62, s62, 32768
  s_waitcnt vmcnt(12)
  s_barrier
  s_add_u32 m0, s59, 16384
  s_nop 0
  buffer_load_dwordx4 v10, s[28:31], s61 offen sc1 lds
  buffer_load_dwordx4 v10, s[28:31], s61 offen offset:1024 sc1 lds
  buffer_load_dwordx4 v10, s[28:31], s61 offen offset:2048 sc1 lds
  buffer_load_dwordx4 v10, s[28:31], s61 offen offset:3072 sc1 lds
  s_add_u32 s61, s61, 8192
  s_add_u32 m0, s63, 49152
  s_nop 0
  buffer_load_dwordx4 v11, s[32:35], s62 offen sc1 lds
  buffer_load_dwordx4 v11, s[32:35], s62 offen offset:1024 sc1 lds
  buffer_load_dwordx4 v11, s[32:35], s62 offen offset:2048 sc1 lds
  buffer_load_dwordx4 v11, s[32:35], s62 offen offset:3072 sc1 lds
  s_add_u32 m0, s63, 53248
  s_nop 0
  buffer_load_dwordx4 v12, s[32:35], s62 offen sc1 lds
  buffer_load_dwordx4 v12, s[32:35], s62 offen offset:1024 sc1 lds
  buffer_load_dwordx4 v12, s[32:35], s62 offen offset:2048 sc1 lds
  buffer_load_dwordx4 v12, s[32:35], s62 offen offset:3072 sc1 lds
  s_add_u32 s62, s62, 32768
  v_lshrrev_b32 v2, 3, v1
  v_and_b32 v3, 7, v1
  v_lshlrev_b32 v2, 10, v2
  v_lshl_add_u32 v22, v3, 4, v2
  s_mov_b32 s36, s20
  s_mov_b32 s37, s21
  s_mov_b32 s38, 1835008
  s_mov_b32 s39, 0x20000
  s_and_b32 s54, s49, 3
  s_mul_i32 s54, s54, 327680
  s_mul_i32 s55, s53, 81920
  s_add_u32 s66, s54, s55
  s_lshl_b32 s54, s50, 7
  s_add_u32 s66, s66, s54
  s_add_u32 s66, s66, 524288
  buffer_load_dwordx4 v[240:243], v22, s[36:39], s66 offen
  s_add_u32 s66, s66, 8192
  buffer_load_dwordx4 v[240:243], v22, s[36:39], s66 offen
  s_add_u32 s66, s66, 8192
  buffer_load_dwordx4 v[240:243], v22, s[36:39], s66 offen
  s_add_u32 s66, s66, 8192
  buffer_load_dwordx4 v[240:243], v22, s[36:39], s66 offen
  s_add_u32 s66, s66, 8192
  buffer_load_dwordx4 v[240:243], v22, s[36:39], s66 offen
  s_add_u32 s66, s66, 8192
  s_waitcnt vmcnt(17)
  s_barrier
  buffer_load_dwordx4 v[240:243], v22, s[36:39], s66 offen
  s_add_u32 s66, s66, 8192
  buffer_load_dwordx4 v[240:243], v22, s[36:39], s66 offen
  s_add_u32 s66, s66, 8192
  buffer_load_dwordx4 v[240:243], v22, s[36:39], s66 offen
  s_add_u32 s66, s66, 8192
  buffer_load_dwordx4 v[240:243], v22, s[36:39], s66 offen
  s_add_u32 s66, s66, 8192
  buffer_load_dwordx4 v[240:243], v22, s[36:39], s66 offen
  s_add_u32 s66, s66, 8192
  s_waitcnt vmcnt(10)
  s_barrier
  s_barrier
  v_lshrrev_b32 v2, 3, v1
  v_and_b32 v3, 7, v1
  s_lshl_b32 s54, s53, 4
  v_add_u32 v5, s54, v2
  v_lshlrev_b32 v5, 10, v5
  v_bfe_u32 v4, v2, 1, 1
  v_lshlrev_b32 v4, 1, v4
  v_xor_b32 v4, v4, v3
  v_lshl_add_u32 v20, v4, 4, v5
  v_xor_b32 v21, 64, v20
  v_add_u32 v21, 8192, v21
  s_mov_b32 s36, s20
  s_mov_b32 s37, s21
  s_mov_b32 s38, 1835008
  s_mov_b32 s39, 0x20000
  s_lshl_b32 s64, s50, 7
  s_lshl_b32 s65, s53, 11
  s_add_u32 m0, s65, 8192
  s_nop 0
  buffer_load_dwordx4 v20, s[36:39], s64 offen lds
  s_add_u32 m0, s65, 9216
  s_nop 0
  buffer_load_dwordx4 v21, s[36:39], s64 offen lds
  s_add_u32 s64, s64, 65536
  s_add_u32 m0, s65, 24576
  s_nop 0
  buffer_load_dwordx4 v20, s[36:39], s64 offen lds
  s_add_u32 m0, s65, 25600
  s_nop 0
  buffer_load_dwordx4 v21, s[36:39], s64 offen lds
  s_add_u32 s64, s64, 65536
  s_add_u32 m0, s65, 40960
  s_nop 0
  buffer_load_dwordx4 v20, s[36:39], s64 offen lds
  s_add_u32 m0, s65, 41984
  s_nop 0
  buffer_load_dwordx4 v21, s[36:39], s64 offen lds
  s_add_u32 s64, s64, 65536
  s_add_u32 m0, s65, 57344
  s_nop 0
  buffer_load_dwordx4 v20, s[36:39], s64 offen lds
  s_add_u32 m0, s65, 58368
  s_nop 0
  buffer_load_dwordx4 v21, s[36:39], s64 offen lds
  s_add_u32 s64, s64, 65536
  s_add_u32 m0, s65, 73728
  s_nop 0
  buffer_load_dwordx4 v20, s[36:39], s64 offen lds
  s_add_u32 m0, s65, 74752
  s_nop 0
  buffer_load_dwordx4 v21, s[36:39], s64 offen lds
  s_add_u32 s64, s64, 65536
  s_add_u32 m0, s65, 90112
  s_nop 0
  buffer_load_dwordx4 v20, s[36:39], s64 offen lds
  s_add_u32 m0, s65, 91136
  s_nop 0
  buffer_load_dwordx4 v21, s[36:39], s64 offen lds
  s_add_u32 s64, s64, 65536
  s_add_u32 m0, s65, 106496
  s_nop 0
  buffer_load_dwordx4 v20, s[36:39], s64 offen lds
  s_add_u32 m0, s65, 107520
  s_nop 0
  buffer_load_dwordx4 v21, s[36:39], s64 offen lds
  s_add_u32 s64, s64, 65536
  s_add_u32 m0, s65, 122880
  s_nop 0
  buffer_load_dwordx4 v20, s[36:39], s64 offen lds
  s_add_u32 m0, s65, 123904
  s_nop 0
  buffer_load_dwordx4 v21, s[36:39], s64 offen lds
  s_add_u32 s64, s64, 65536
  v_subrev_u32 v23, 256, v0
  s_mov_b32 s56, 0x12492493
  s_mov_b32 s57, 3584
  v_add_u32 v24, 0, v23
  v_mul_hi_u32 v25, v24, s56
  v_mul_u32_u24 v26, 14, v25
  v_sub_u32 v26, v24, v26
  v_lshrrev_b32 v27, 5, v25
  v_and_b32 v25, 31, v25
  v_lshl_add_u32 v25, v27, 6, v25
  v_mul_u32_u24 v28, 240, v25
  v_lshl_add_u32 v28, v26, 4, v28
  v_add_u32 v28, 131072, v28
  v_mul_lo_u32 v32, v25, s57
  v_lshl_add_u32 v32, v26, 4, v32
  v_add_u32 v24, 256, v23
  v_mul_hi_u32 v25, v24, s56
  v_mul_u32_u24 v26, 14, v25
  v_sub_u32 v26, v24, v26
  v_lshrrev_b32 v27, 5, v25
  v_and_b32 v25, 31, v25
  v_lshl_add_u32 v25, v27, 6, v25
  v_mul_u32_u24 v29, 240, v25
  v_lshl_add_u32 v29, v26, 4, v29
  v_add_u32 v29, 131072, v29
  v_mul_lo_u32 v33, v25, s57
  v_lshl_add_u32 v33, v26, 4, v33
  v_add_u32 v24, 512, v23
  v_mul_hi_u32 v25, v24, s56
  v_mul_u32_u24 v26, 14, v25
  v_sub_u32 v26, v24, v26
  v_lshrrev_b32 v27, 5, v25
  v_and_b32 v25, 31, v25
  v_lshl_add_u32 v25, v27, 6, v25
  v_mul_u32_u24 v30, 240, v25
  v_lshl_add_u32 v30, v26, 4, v30
  v_add_u32 v30, 131072, v30
  v_mul_lo_u32 v34, v25, s57
  v_lshl_add_u32 v34, v26, 4, v34
  v_add_u32 v24, 768, v23
  v_mul_hi_u32 v25, v24, s56
  v_mul_u32_u24 v26, 14, v25
  v_sub_u32 v26, v24, v26
  v_lshrrev_b32 v27, 5, v25
  v_and_b32 v25, 31, v25
  v_lshl_add_u32 v25, v27, 6, v25
  v_mul_u32_u24 v31, 240, v25
  v_lshl_add_u32 v31, v26, 4, v31
  v_add_u32 v31, 131072, v31
  v_mul_lo_u32 v35, v25, s57
  v_lshl_add_u32 v35, v26, 4, v35
  v_mov_b32 v27, 0x7fffffff
  v_cmp_gt_u32 vcc, 896, v24
  s_nop 1
  v_cndmask_b32 v35, v27, v35, vcc
  v_mov_b32 v27, 131072
  v_cndmask_b32 v31, v27, v31, vcc
  s_barrier
  ds_read_b128 v[40:43], v28
  ds_read_b128 v[44:47], v29
  ds_read_b128 v[48:51], v30
  ds_read_b128 v[52:55], v31
  s_waitcnt lgkmcnt(3)
  buffer_store_dwordx4 v[40:43], v32, s[40:43], s68 offen sc1
  s_waitcnt lgkmcnt(2)
  buffer_store_dwordx4 v[44:47], v33, s[40:43], s68 offen sc1
  s_waitcnt lgkmcnt(1)
  buffer_store_dwordx4 v[48:51], v34, s[40:43], s68 offen sc1
  s_waitcnt lgkmcnt(0)
  buffer_store_dwordx4 v[52:55], v35, s[40:43], s68 offen sc1
Ljoin_49:
  s_waitcnt lgkmcnt(0)
  s_barrier
  ds_read_b128 v[36:39], v244
  ds_read_b128 v[40:43], v245
  s_waitcnt lgkmcnt(1)
  buffer_store_dwordx4 v[36:39], v246, s[40:43], s68 offen sc1
  s_waitcnt lgkmcnt(0)
  buffer_store_dwordx4 v[40:43], v247, s[40:43], s68 offen sc1
  s_lshl_b32 s58, s0, 4
  s_add_u32 s58, s58, s1
  s_mov_b32 s14, s58
  s_lshr_b32 s7, s48, 2
  s_bfe_u32 s52, s48, 0x10001
  s_and_b32 s53, s48, 1
  v_lshrrev_b32 v2, 3, v1
  v_and_b32 v3, 7, v1
  v_bfe_u32 v4, v2, 1, 1
  s_and_b32 s54, s48, 1
  s_lshl_b32 s54, s54, 1
  v_or_b32 v4, s54, v4
  v_lshlrev_b32 v4, 1, v4
  v_xor_b32 v3, v3, v4
  v_lshlrev_b32 v3, 4, v3
  s_lshl_b32 s54, s48, 3
  v_add_u32 v2, s54, v2
  s_mov_b32 s54, 1024
  v_mul_lo_u32 v2, v2, s54
  v_add_u32 v11, v2, v3
  s_mov_b32 s32, s20
  s_mov_b32 s33, s21
  s_mov_b32 s34, 1835008
  s_mov_b32 s35, 0x20000
  s_lshl_b32 s62, s50, 7
  s_and_b32 s59, s49, 3
  s_mul_i32 s59, s59, 7
  s_add_u32 s62, s62, 524288
  v_lshrrev_b32 v2, 3, v1
  v_and_b32 v3, 7, v1
  v_xor_b32 v3, v2, v3
  v_lshlrev_b32 v3, 4, v3
  s_lshl_b32 s54, s48, 3
  v_add_u32 v2, s54, v2
  s_mov_b32 s54, 3584
  v_mul_lo_u32 v2, v2, s54
  v_add_u32 v10, v2, v3
  s_lshl_b32 s57, s52, 12
  v_and_b32 v2, 15, v1
  v_lshrrev_b32 v3, 4, v1
  v_and_b32 v4, 7, v2
  v_xor_b32 v3, v3, v4
  v_lshlrev_b32 v3, 4, v3
  v_lshl_add_u32 v12, v2, 7, v3
  v_add_u32 v12, s57, v12
  v_xor_b32 v18, 64, v12
  s_cmp_eq_u32 s7, 1
  s_cselect_b32 s54, 64, 0
  v_xor_b32 v12, s54, v12
  v_add_u32 v13, 0x10000, v12
  s_lshl_b32 s55, s53, 1
  s_add_u32 s55, s55, 0
  v_lshrrev_b32 v2, 4, v1
  v_bfe_u32 v3, v1, 2, 2
  v_lshl_add_u32 v14, v2, 3, v3
  v_lshlrev_b32 v14, 7, v14
  v_bfe_u32 v3, v1, 3, 1
  v_and_b32 v2, 1, v2
  v_lshl_add_u32 v3, v2, 1, v3
  v_xor_b32 v3, s55, v3
  v_lshl_add_u32 v14, v3, 5, v14
  v_and_b32 v4, 3, v1
  v_lshl_add_u32 v14, v4, 3, v14
  s_lshl_b32 s54, s7, 12
  v_add_u32 v14, s54, v14
  v_add_u32 v16, 0x10000, v14
  s_lshl_b32 s55, s53, 1
  s_add_u32 s55, s55, 1
  v_lshrrev_b32 v2, 4, v1
  v_bfe_u32 v3, v1, 2, 2
  v_lshl_add_u32 v15, v2, 3, v3
  v_lshlrev_b32 v15, 7, v15
  v_bfe_u32 v3, v1, 3, 1
  v_and_b32 v2, 1, v2
  v_lshl_add_u32 v3, v2, 1, v3
  v_xor_b32 v3, s55, v3
  v_lshl_add_u32 v15, v3, 5, v15
  v_and_b32 v4, 3, v1
  v_lshl_add_u32 v15, v4, 3, v15
  s_lshl_b32 s54, s7, 12
  v_add_u32 v15, s54, v15
  v_add_u32 v17, 0x10000, v15
  v_mov_b32 v20, 0
  v_mov_b32 v21, 0
  v_mov_b32 v22, 0
  v_mov_b32 v23, 0
  v_mov_b32 v24, 0
  v_mov_b32 v25, 0
  v_mov_b32 v26, 0
  v_mov_b32 v27, 0
  v_mov_b32 v28, 0
  v_mov_b32 v29, 0
  v_mov_b32 v30, 0
  v_mov_b32 v31, 0
  v_mov_b32 v32, 0
  v_mov_b32 v33, 0
  v_mov_b32 v34, 0
  v_mov_b32 v35, 0
  s_add_u32 s28, s26, 11534336
  s_addc_u32 s29, s27, 0
  s_mov_b32 s30, 7340032
  s_mov_b32 s31, 0x20000
  s_mov_b32 s40, s22
  s_mov_b32 s41, s23
  s_mov_b32 s42, 2097152
  s_mov_b32 s43, 0x20000
  s_mul_i32 s61, s49, 229376
  v_lshrrev_b32 v2, 3, v0
  v_and_b32 v3, 7, v0
  v_lshlrev_b32 v2, 10, v2
  v_lshl_add_u32 v8, v3, 4, v2
  s_lshl_b32 s54, s49, 16
  s_lshl_b32 s55, s50, 7
  s_add_u32 s54, s54, s55
  v_add_u32 v8, s54, v8
  s_lshl_b32 s58, s49, 3
  s_add_u32 s58, s58, s50
  s_lshl_b32 s54, s58, 13
  v_lshlrev_b32 v9, 4, v0
  v_add_u32 v9, s54, v9
  v_and_b32 v5, 15, v1
  s_lshr_b32 s54, s49, 1
  s_lshl_b32 s54, s54, 4
  v_add_u32 v5, s54, v5
  v_lshlrev_b32 v5, 7, v5
  v_add_u32 v5, 131072, v5
  v_and_b32 v2, 15, v1
  v_lshrrev_b32 v3, 4, v1
  s_lshl_b32 s54, s7, 14
  s_lshl_b32 s55, s52, 13
  s_add_u32 s54, s54, s55
  s_lshl_b32 s55, s53, 3
  v_add_u32 v4, s55, v3
  v_xor_b32 v4, v4, v2
  v_lshlrev_b32 v4, 4, v4
  v_lshl_add_u32 v4, v2, 8, v4
  v_add_u32 v72, s54, v4
  v_add_u32 v4, s55, v3
  v_add_u32 v4, 4, v4
  v_xor_b32 v4, v4, v2
  v_lshlrev_b32 v4, 4, v4
  v_lshl_add_u32 v4, v2, 8, v4
  v_add_u32 v73, s54, v4
  v_lshrrev_b32 v2, 3, v0
  v_and_b32 v3, 7, v0
  v_lshlrev_b32 v3, 1, v3
  v_and_b32 v4, 15, v2
  v_xor_b32 v3, v3, v4
  v_lshlrev_b32 v3, 4, v3
  v_lshl_add_u32 v74, v2, 8, v3
  v_xor_b32 v75, 16, v74
  s_waitcnt vmcnt(0)
  s_barrier
  s_cmp_eq_u32 s48, 0
  s_cbranch_scc0 Lsig_58
  s_lshl_b32 s54, s14, 7
  s_add_u32 s54, s54, 131072
  v_mov_b32 v2, s4
  v_mov_b32 v3, 0
  s_mov_b64 exec, 1
  buffer_store_dword v2, v3, s[44:47], s54 offen sc1
  s_mov_b64 exec, -1
Lsig_58:
  s_cmp_eq_u32 s48, 0
  s_cbranch_scc0 Lw_59
  s_mov_b32 s3, 0
Lp_60:
  buffer_load_dword v2, v5, s[44:47], 0 offen sc1
  s_waitcnt vmcnt(0)
  v_cmp_ne_u32 vcc, s4, v2
  s_nop 0
  s_and_b32 s71, vcc_lo, 7
  s_cbranch_scc0 Lo_61
  s_add_u32 s3, s3, 1
  s_cmp_lt_u32 s3, 400000
  s_cbranch_scc1 Lp_60
Lo_61:
Lw_59:
  s_barrier
  s_add_u32 m0, s51, 0
  s_nop 0
  buffer_load_dwordx4 v10, s[28:31], s61 offen sc1 lds
  s_add_u32 s61, s61, 128
  s_add_u32 m0, s51, 16384
  s_nop 0
  buffer_load_dwordx4 v10, s[28:31], s61 offen sc1 lds
  s_add_u32 s61, s61, 128
  s_add_u32 m0, s51, 32768
  s_nop 0
  buffer_load_dwordx4 v10, s[28:31], s61 offen sc1 lds
  s_add_u32 s61, s61, 128
  s_add_u32 m0, s51, 49152
  s_nop 0
  buffer_load_dwordx4 v10, s[28:31], s61 offen sc1 lds
  s_add_u32 s61, s61, 128
  s_cmp_eq_u32 s48, 0
  s_cbranch_scc0 Lw_62
  s_mov_b32 s3, 0
Lp_63:
  buffer_load_dword v2, v5, s[44:47], 0 offen sc1
  s_waitcnt vmcnt(0)
  v_cmp_ne_u32 vcc, s4, v2
  s_cbranch_vccz Lo_64
  s_add_u32 s3, s3, 1
  s_cmp_lt_u32 s3, 400000
  s_cbranch_scc1 Lp_63
Lo_64:
Lw_62:
  s_waitcnt vmcnt(2)
  s_barrier
  ds_read_b128 v[40:43], v12 offset:0
  ds_read_b128 v[44:47], v12 offset:2048
  ds_read_b64_tr_b16 v[48:49], v14 offset:8192
  ds_read_b64_tr_b16 v[50:51], v14 offset:8704
  ds_read_b64_tr_b16 v[52:53], v15 offset:8192
  ds_read_b64_tr_b16 v[54:55], v15 offset:8704
  s_waitcnt lgkmcnt(0)
  v_mfma_f32_16x16x32_bf16 v[20:23], v[48:51], v[40:43], v[20:23]
  ds_read_b128 v[56:59], v12 offset:16384
  ds_read_b128 v[60:63], v12 offset:18432
  s_add_u32 m0, s51, 65536
  s_nop 0
  buffer_load_dwordx4 v10, s[28:31], s61 offen sc1 lds
  s_add_u32 s61, s61, 128
  v_mfma_f32_16x16x32_bf16 v[24:27], v[48:51], v[44:47], v[24:27]
  ds_read_b64_tr_b16 v[64:65], v14 offset:24576
  ds_read_b64_tr_b16 v[66:67], v14 offset:25088
  s_add_u32 m0, s51, 81920
  s_nop 0
  buffer_load_dwordx4 v10, s[28:31], s61 offen sc1 lds
  s_add_u32 s61, s61, 128
  v_mfma_f32_16x16x32_bf16 v[28:31], v[52:55], v[40:43], v[28:31]
  ds_read_b64_tr_b16 v[68:69], v15 offset:24576
  ds_read_b64_tr_b16 v[70:71], v15 offset:25088
  s_add_u32 m0, s51, 98304
  s_nop 0
  buffer_load_dwordx4 v10, s[28:31], s61 offen sc1 lds
  s_add_u32 s61, s61, 128
  v_mfma_f32_16x16x32_bf16 v[32:35], v[52:55], v[44:47], v[32:35]
  s_add_u32 m0, s51, 114688
  s_nop 0
  buffer_load_dwordx4 v10, s[28:31], s61 offen sc1 lds
  s_add_u32 s61, s61, 128
  s_waitcnt lgkmcnt(0)
  s_waitcnt vmcnt(4)
  s_barrier
  v_mfma_f32_16x16x32_bf16 v[20:23], v[64:67], v[56:59], v[20:23]
  ds_read_b128 v[40:43], v12 offset:32768
  ds_read_b128 v[44:47], v12 offset:34816
  v_mfma_f32_16x16x32_bf16 v[24:27], v[64:67], v[60:63], v[24:27]
  ds_read_b64_tr_b16 v[48:49], v14 offset:40960
  ds_read_b64_tr_b16 v[50:51], v14 offset:41472
  s_add_u32 m0, s51, 8192
  s_nop 0
  buffer_load_dwordx4 v11, s[32:35], s62 offen lds
  s_add_u32 s62, s62, 65536
  v_mfma_f32_16x16x32_bf16 v[28:31], v[68:71], v[56:59], v[28:31]
  ds_read_b64_tr_b16 v[52:53], v15 offset:40960
  ds_read_b64_tr_b16 v[54:55], v15 offset:41472
  v_mfma_f32_16x16x32_bf16 v[32:35], v[68:71], v[60:63], v[32:35]
  s_add_u32 m0, s51, 0
  s_nop 0
  buffer_load_dwordx4 v10, s[28:31], s61 offen sc1 lds
  s_add_u32 s61, s61, 128
  s_waitcnt lgkmcnt(0)
  v_mfma_f32_16x16x32_bf16 v[20:23], v[48:51], v[40:43], v[20:23]
  ds_read_b128 v[56:59], v12 offset:49152
  ds_read_b128 v[60:63], v12 offset:51200
  v_mfma_f32_16x16x32_bf16 v[24:27], v[48:51], v[44:47], v[24:27]
  ds_read_b64_tr_b16 v[64:65], v14 offset:57344
  ds_read_b64_tr_b16 v[66:67], v14 offset:57856
  s_add_u32 m0, s51, 24576
  s_nop 0
  buffer_load_dwordx4 v11, s[32:35], s62 offen lds
  s_add_u32 s62, s62, 65536
  v_mfma_f32_16x16x32_bf16 v[28:31], v[52:55], v[40:43], v[28:31]
  ds_read_b64_tr_b16 v[68:69], v15 offset:57344
  ds_read_b64_tr_b16 v[70:71], v15 offset:57856
  v_mfma_f32_16x16x32_bf16 v[32:35], v[52:55], v[44:47], v[32:35]
  s_add_u32 m0, s51, 16384
  s_nop 0
  buffer_load_dwordx4 v10, s[28:31], s61 offen sc1 lds
  s_add_u32 s61, s61, 128
  s_waitcnt lgkmcnt(0)
  s_waitcnt vmcnt(6)
  s_barrier
  v_mfma_f32_16x16x32_bf16 v[20:23], v[64:67], v[56:59], v[20:23]
  ds_read_b128 v[40:43], v13 offset:0
  ds_read_b128 v[44:47], v13 offset:2048
  v_mfma_f32_16x16x32_bf16 v[24:27], v[64:67], v[60:63], v[24:27]
  ds_read_b64_tr_b16 v[48:49], v16 offset:8192
  ds_read_b64_tr_b16 v[50:51], v16 offset:8704
  s_add_u32 m0, s51, 40960
  s_nop 0
  buffer_load_dwordx4 v11, s[32:35], s62 offen lds
  s_add_u32 s62, s62, 65536
  v_mfma_f32_16x16x32_bf16 v[28:31], v[68:71], v[56:59], v[28:31]
  ds_read_b64_tr_b16 v[52:53], v17 offset:8192
  ds_read_b64_tr_b16 v[54:55], v17 offset:8704
  v_mfma_f32_16x16x32_bf16 v[32:35], v[68:71], v[60:63], v[32:35]
  s_add_u32 m0, s51, 32768
  s_nop 0
  buffer_load_dwordx4 v10, s[28:31], s61 offen sc1 lds
  s_add_u32 s61, s61, 128
  s_waitcnt lgkmcnt(0)
  v_mfma_f32_16x16x32_bf16 v[20:23], v[48:51], v[40:43], v[20:23]
  ds_read_b128 v[56:59], v13 offset:16384
  ds_read_b128 v[60:63], v13 offset:18432
  v_mfma_f32_16x16x32_bf16 v[24:27], v[48:51], v[44:47], v[24:27]
  ds_read_b64_tr_b16 v[64:65], v16 offset:24576
  ds_read_b64_tr_b16 v[66:67], v16 offset:25088
  s_add_u32 m0, s51, 57344
  s_nop 0
  buffer_load_dwordx4 v11, s[32:35], s62 offen lds
  s_add_u32 s62, s62, 65536
  v_mfma_f32_16x16x32_bf16 v[28:31], v[52:55], v[40:43], v[28:31]
  ds_read_b64_tr_b16 v[68:69], v17 offset:24576
  ds_read_b64_tr_b16 v[70:71], v17 offset:25088
  v_mfma_f32_16x16x32_bf16 v[32:35], v[52:55], v[44:47], v[32:35]
  s_add_u32 m0, s51, 49152
  s_nop 0
  buffer_load_dwordx4 v10, s[28:31], s61 offen sc1 lds
  s_add_u32 s61, s61, 128
  s_waitcnt lgkmcnt(0)
  s_waitcnt vmcnt(8)
  s_barrier
  v_mfma_f32_16x16x32_bf16 v[20:23], v[64:67], v[56:59], v[20:23]
  ds_read_b128 v[40:43], v13 offset:32768
  ds_read_b128 v[44:47], v13 offset:34816
  v_mfma_f32_16x16x32_bf16 v[24:27], v[64:67], v[60:63], v[24:27]
  ds_read_b64_tr_b16 v[48:49], v16 offset:40960
  ds_read_b64_tr_b16 v[50:51], v16 offset:41472
  s_add_u32 m0, s51, 73728
  s_nop 0
  buffer_load_dwordx4 v11, s[32:35], s62 offen lds
  s_add_u32 s62, s62, 65536
  v_mfma_f32_16x16x32_bf16 v[28:31], v[68:71], v[56:59], v[28:31]
  ds_read_b64_tr_b16 v[52:53], v17 offset:40960
  ds_read_b64_tr_b16 v[54:55], v17 offset:41472
  v_mfma_f32_16x16x32_bf16 v[32:35], v[68:71], v[60:63], v[32:35]
  s_add_u32 m0, s51, 65536
  s_nop 0
  buffer_load_dwordx4 v10, s[28:31], s61 offen sc1 lds
  s_add_u32 s61, s61, 128
  s_waitcnt lgkmcnt(0)
  v_mfma_f32_16x16x32_bf16 v[20:23], v[48:51], v[40:43], v[20:23]
  ds_read_b128 v[56:59], v13 offset:49152
  ds_read_b128 v[60:63], v13 offset:51200
  v_mfma_f32_16x16x32_bf16 v[24:27], v[48:51], v[44:47], v[24:27]
  ds_read_b64_tr_b16 v[64:65], v16 offset:57344
  ds_read_b64_tr_b16 v[66:67], v16 offset:57856
  s_add_u32 m0, s51, 90112
  s_nop 0
  buffer_load_dwordx4 v11, s[32:35], s62 offen lds
  s_add_u32 s62, s62, 65536
  v_mfma_f32_16x16x32_bf16 v[28:31], v[52:55], v[40:43], v[28:31]
  ds_read_b64_tr_b16 v[68:69], v17 offset:57344
  ds_read_b64_tr_b16 v[70:71], v17 offset:57856
  v_mfma_f32_16x16x32_bf16 v[32:35], v[52:55], v[44:47], v[32:35]
  s_add_u32 m0, s51, 81920
  s_nop 0
  buffer_load_dwordx4 v10, s[28:31], s61 offen sc1 lds
  s_add_u32 s61, s61, 128
  s_waitcnt lgkmcnt(0)
  s_waitcnt vmcnt(8)
  s_barrier
  v_mfma_f32_16x16x32_bf16 v[20:23], v[64:67], v[56:59], v[20:23]
  ds_read_b128 v[40:43], v12 offset:0
  ds_read_b128 v[44:47], v12 offset:2048
  v_mfma_f32_16x16x32_bf16 v[24:27], v[64:67], v[60:63], v[24:27]
  ds_read_b64_tr_b16 v[48:49], v14 offset:8192
  ds_read_b64_tr_b16 v[50:51], v14 offset:8704
  s_add_u32 m0, s51, 106496
  s_nop 0
  buffer_load_dwordx4 v11, s[32:35], s62 offen lds
  s_add_u32 s62, s62, 65536
  v_mfma_f32_16x16x32_bf16 v[28:31], v[68:71], v[56:59], v[28:31]
  ds_read_b64_tr_b16 v[52:53], v15 offset:8192
  ds_read_b64_tr_b16 v[54:55], v15 offset:8704
  v_mfma_f32_16x16x32_bf16 v[32:35], v[68:71], v[60:63], v[32:35]
  s_add_u32 m0, s51, 98304
  s_nop 0
  buffer_load_dwordx4 v10, s[28:31], s61 offen sc1 lds
  s_add_u32 s61, s61, 128
  s_waitcnt lgkmcnt(0)
  v_mfma_f32_16x16x32_bf16 v[20:23], v[48:51], v[40:43], v[20:23]
  ds_read_b128 v[56:59], v12 offset:16384
  ds_read_b128 v[60:63], v12 offset:18432
  v_mfma_f32_16x16x32_bf16 v[24:27], v[48:51], v[44:47], v[24:27]
  ds_read_b64_tr_b16 v[64:65], v14 offset:24576
  ds_read_b64_tr_b16 v[66:67], v14 offset:25088
  s_add_u32 m0, s51, 122880
  s_nop 0
  buffer_load_dwordx4 v11, s[32:35], s62 offen lds
  s_add_u32 s62, s62, 65536
  v_mfma_f32_16x16x32_bf16 v[28:31], v[52:55], v[40:43], v[28:31]
  ds_read_b64_tr_b16 v[68:69], v15 offset:24576
  ds_read_b64_tr_b16 v[70:71], v15 offset:25088
  v_mfma_f32_16x16x32_bf16 v[32:35], v[52:55], v[44:47], v[32:35]
  s_add_u32 m0, s51, 114688
  s_nop 0
  buffer_load_dwordx4 v10, s[28:31], s61 offen sc1 lds
  s_add_u32 s61, s61, 128
  s_waitcnt lgkmcnt(0)
  s_waitcnt vmcnt(8)
  s_barrier
  v_mfma_f32_16x16x32_bf16 v[20:23], v[64:67], v[56:59], v[20:23]
  ds_read_b128 v[40:43], v12 offset:32768
  ds_read_b128 v[44:47], v12 offset:34816
  v_mfma_f32_16x16x32_bf16 v[24:27], v[64:67], v[60:63], v[24:27]
  ds_read_b64_tr_b16 v[48:49], v14 offset:40960
  ds_read_b64_tr_b16 v[50:51], v14 offset:41472
  s_add_u32 m0, s51, 8192
  s_nop 0
  buffer_load_dwordx4 v11, s[32:35], s62 offen lds
  s_add_u32 s62, s62, 65536
  v_mfma_f32_16x16x32_bf16 v[28:31], v[68:71], v[56:59], v[28:31]
  ds_read_b64_tr_b16 v[52:53], v15 offset:40960
  ds_read_b64_tr_b16 v[54:55], v15 offset:41472
  v_mfma_f32_16x16x32_bf16 v[32:35], v[68:71], v[60:63], v[32:35]
  s_add_u32 m0, s51, 0
  s_nop 0
  buffer_load_dwordx4 v10, s[28:31], s61 offen sc1 lds
  s_add_u32 s61, s61, 128
  s_waitcnt lgkmcnt(0)
  v_mfma_f32_16x16x32_bf16 v[20:23], v[48:51], v[40:43], v[20:23]
  ds_read_b128 v[56:59], v12 offset:49152
  ds_read_b128 v[60:63], v12 offset:51200
  v_mfma_f32_16x16x32_bf16 v[24:27], v[48:51], v[44:47], v[24:27]
  ds_read_b64_tr_b16 v[64:65], v14 offset:57344
  ds_read_b64_tr_b16 v[66:67], v14 offset:57856
  s_add_u32 m0, s51, 24576
  s_nop 0
  buffer_load_dwordx4 v11, s[32:35], s62 offen lds
  s_add_u32 s62, s62, 65536
  v_mfma_f32_16x16x32_bf16 v[28:31], v[52:55], v[40:43], v[28:31]
  ds_read_b64_tr_b16 v[68:69], v15 offset:57344
  ds_read_b64_tr_b16 v[70:71], v15 offset:57856
  v_mfma_f32_16x16x32_bf16 v[32:35], v[52:55], v[44:47], v[32:35]
  s_add_u32 m0, s51, 16384
  s_nop 0
  buffer_load_dwordx4 v10, s[28:31], s61 offen sc1 lds
  s_add_u32 s61, s61, 128
  s_waitcnt lgkmcnt(0)
  s_waitcnt vmcnt(8)
  s_barrier
  v_mfma_f32_16x16x32_bf16 v[20:23], v[64:67], v[56:59], v[20:23]
  ds_read_b128 v[40:43], v13 offset:0
  ds_read_b128 v[44:47], v13 offset:2048
  v_mfma_f32_16x16x32_bf16 v[24:27], v[64:67], v[60:63], v[24:27]
  ds_read_b64_tr_b16 v[48:49], v16 offset:8192
  ds_read_b64_tr_b16 v[50:51], v16 offset:8704
  s_add_u32 m0, s51, 40960
  s_nop 0
  buffer_load_dwordx4 v11, s[32:35], s62 offen lds
  s_add_u32 s62, s62, 65536
  v_mfma_f32_16x16x32_bf16 v[28:31], v[68:71], v[56:59], v[28:31]
  ds_read_b64_tr_b16 v[52:53], v17 offset:8192
  ds_read_b64_tr_b16 v[54:55], v17 offset:8704
  v_mfma_f32_16x16x32_bf16 v[32:35], v[68:71], v[60:63], v[32:35]
  s_add_u32 m0, s51, 32768
  s_nop 0
  buffer_load_dwordx4 v10, s[28:31], s61 offen sc1 lds
  s_add_u32 s61, s61, 128
  s_waitcnt lgkmcnt(0)
  v_mfma_f32_16x16x32_bf16 v[20:23], v[48:51], v[40:43], v[20:23]
  ds_read_b128 v[56:59], v13 offset:16384
  ds_read_b128 v[60:63], v13 offset:18432
  v_mfma_f32_16x16x32_bf16 v[24:27], v[48:51], v[44:47], v[24:27]
  ds_read_b64_tr_b16 v[64:65], v16 offset:24576
  ds_read_b64_tr_b16 v[66:67], v16 offset:25088
  s_add_u32 m0, s51, 57344
  s_nop 0
  buffer_load_dwordx4 v11, s[32:35], s62 offen lds
  s_add_u32 s62, s62, 65536
  v_mfma_f32_16x16x32_bf16 v[28:31], v[52:55], v[40:43], v[28:31]
  ds_read_b64_tr_b16 v[68:69], v17 offset:24576
  ds_read_b64_tr_b16 v[70:71], v17 offset:25088
  v_mfma_f32_16x16x32_bf16 v[32:35], v[52:55], v[44:47], v[32:35]
  s_add_u32 m0, s51, 49152
  s_nop 0
  buffer_load_dwordx4 v10, s[28:31], s61 offen sc1 lds
  s_add_u32 s61, s61, 128
  s_waitcnt lgkmcnt(0)
  s_waitcnt vmcnt(8)
  s_barrier
  v_mfma_f32_16x16x32_bf16 v[20:23], v[64:67], v[56:59], v[20:23]
  ds_read_b128 v[40:43], v13 offset:32768
  ds_read_b128 v[44:47], v13 offset:34816
  v_mfma_f32_16x16x32_bf16 v[24:27], v[64:67], v[60:63], v[24:27]
  ds_read_b64_tr_b16 v[48:49], v16 offset:40960
  ds_read_b64_tr_b16 v[50:51], v16 offset:41472
  s_add_u32 m0, s51, 73728
  s_nop 0
  buffer_load_dwordx4 v11, s[32:35], s62 offen lds
  s_add_u32 s62, s62, 65536
  v_mfma_f32_16x16x32_bf16 v[28:31], v[68:71], v[56:59], v[28:31]
  ds_read_b64_tr_b16 v[52:53], v17 offset:40960
  ds_read_b64_tr_b16 v[54:55], v17 offset:41472
  v_mfma_f32_16x16x32_bf16 v[32:35], v[68:71], v[60:63], v[32:35]
  s_add_u32 m0, s51, 65536
  s_nop 0
  buffer_load_dwordx4 v10, s[28:31], s61 offen sc1 lds
  s_add_u32 s61, s61, 128
  s_waitcnt lgkmcnt(0)
  v_mfma_f32_16x16x32_bf16 v[20:23], v[48:51], v[40:43], v[20:23]
  ds_read_b128 v[56:59], v13 offset:49152
  ds_read_b128 v[60:63], v13 offset:51200
  v_mfma_f32_16x16x32_bf16 v[24:27], v[48:51], v[44:47], v[24:27]
  ds_read_b64_tr_b16 v[64:65], v16 offset:57344
  ds_read_b64_tr_b16 v[66:67], v16 offset:57856
  s_add_u32 m0, s51, 90112
  s_nop 0
  buffer_load_dwordx4 v11, s[32:35], s62 offen lds
  s_add_u32 s62, s62, 65536
  v_mfma_f32_16x16x32_bf16 v[28:31], v[52:55], v[40:43], v[28:31]
  ds_read_b64_tr_b16 v[68:69], v17 offset:57344
  ds_read_b64_tr_b16 v[70:71], v17 offset:57856
  v_mfma_f32_16x16x32_bf16 v[32:35], v[52:55], v[44:47], v[32:35]
  s_add_u32 m0, s51, 81920
  s_nop 0
  buffer_load_dwordx4 v10, s[28:31], s61 offen sc1 lds
  s_add_u32 s61, s61, 128
  s_waitcnt lgkmcnt(0)
  s_waitcnt vmcnt(8)
  s_barrier
  v_mfma_f32_16x16x32_bf16 v[20:23], v[64:67], v[56:59], v[20:23]
  ds_read_b128 v[40:43], v12 offset:0
  ds_read_b128 v[44:47], v12 offset:2048
  v_mfma_f32_16x16x32_bf16 v[24:27], v[64:67], v[60:63], v[24:27]
  ds_read_b64_tr_b16 v[48:49], v14 offset:8192
  ds_read_b64_tr_b16 v[50:51], v14 offset:8704
  s_add_u32 m0, s51, 106496
  s_nop 0
  buffer_load_dwordx4 v11, s[32:35], s62 offen lds
  s_add_u32 s62, s62, 65536
  v_mfma_f32_16x16x32_bf16 v[28:31], v[68:71], v[56:59], v[28:31]
  ds_read_b64_tr_b16 v[52:53], v15 offset:8192
  ds_read_b64_tr_b16 v[54:55], v15 offset:8704
  v_mfma_f32_16x16x32_bf16 v[32:35], v[68:71], v[60:63], v[32:35]
  s_add_u32 m0, s51, 98304
  s_nop 0
  buffer_load_dwordx4 v10, s[28:31], s61 offen sc1 lds
  s_add_u32 s61, s61, 128
  s_waitcnt lgkmcnt(0)
  v_mfma_f32_16x16x32_bf16 v[20:23], v[48:51], v[40:43], v[20:23]
  ds_read_b128 v[56:59], v12 offset:16384
  ds_read_b128 v[60:63], v12 offset:18432
  v_mfma_f32_16x16x32_bf16 v[24:27], v[48:51], v[44:47], v[24:27]
  ds_read_b64_tr_b16 v[64:65], v14 offset:24576
  ds_read_b64_tr_b16 v[66:67], v14 offset:25088
  s_add_u32 m0, s51, 122880
  s_nop 0
  buffer_load_dwordx4 v11, s[32:35], s62 offen lds
  s_add_u32 s62, s62, 65536
  v_mfma_f32_16x16x32_bf16 v[28:31], v[52:55], v[40:43], v[28:31]
  ds_read_b64_tr_b16 v[68:69], v15 offset:24576
  ds_read_b64_tr_b16 v[70:71], v15 offset:25088
  v_mfma_f32_16x16x32_bf16 v[32:35], v[52:55], v[44:47], v[32:35]
  s_add_u32 m0, s51, 114688
  s_nop 0
  buffer_load_dwordx4 v10, s[28:31], s61 offen sc1 lds
  s_add_u32 s61, s61, 128
  s_waitcnt lgkmcnt(0)
  s_waitcnt vmcnt(8)
  s_barrier
  v_mfma_f32_16x16x32_bf16 v[20:23], v[64:67], v[56:59], v[20:23]
  ds_read_b128 v[40:43], v12 offset:32768
  ds_read_b128 v[44:47], v12 offset:34816
  v_mfma_f32_16x16x32_bf16 v[24:27], v[64:67], v[60:63], v[24:27]
  ds_read_b64_tr_b16 v[48:49], v14 offset:40960
  ds_read_b64_tr_b16 v[50:51], v14 offset:41472
  s_add_u32 m0, s51, 8192
  s_nop 0
  buffer_load_dwordx4 v11, s[32:35], s62 offen lds
  s_add_u32 s62, s62, 65536
  v_mfma_f32_16x16x32_bf16 v[28:31], v[68:71], v[56:59], v[28:31]
  ds_read_b64_tr_b16 v[52:53], v15 offset:40960
  ds_read_b64_tr_b16 v[54:55], v15 offset:41472
  v_mfma_f32_16x16x32_bf16 v[32:35], v[68:71], v[60:63], v[32:35]
  s_add_u32 m0, s51, 0
  s_nop 0
  buffer_load_dwordx4 v10, s[28:31], s61 offen sc1 lds
  s_add_u32 s61, s61, 128
  s_waitcnt lgkmcnt(0)
  v_mfma_f32_16x16x32_bf16 v[20:23], v[48:51], v[40:43], v[20:23]
  ds_read_b128 v[56:59], v12 offset:49152
  ds_read_b128 v[60:63], v12 offset:51200
  v_mfma_f32_16x16x32_bf16 v[24:27], v[48:51], v[44:47], v[24:27]
  ds_read_b64_tr_b16 v[64:65], v14 offset:57344
  ds_read_b64_tr_b16 v[66:67], v14 offset:57856
  s_add_u32 m0, s51, 24576
  s_nop 0
  buffer_load_dwordx4 v11, s[32:35], s62 offen lds
  s_add_u32 s62, s62, 65536
  v_mfma_f32_16x16x32_bf16 v[28:31], v[52:55], v[40:43], v[28:31]
  ds_read_b64_tr_b16 v[68:69], v15 offset:57344
  ds_read_b64_tr_b16 v[70:71], v15 offset:57856
  v_mfma_f32_16x16x32_bf16 v[32:35], v[52:55], v[44:47], v[32:35]
  s_add_u32 m0, s51, 16384
  s_nop 0
  buffer_load_dwordx4 v10, s[28:31], s61 offen sc1 lds
  s_add_u32 s61, s61, 128
  s_waitcnt lgkmcnt(0)
  s_waitcnt vmcnt(8)
  s_barrier
  v_mfma_f32_16x16x32_bf16 v[20:23], v[64:67], v[56:59], v[20:23]
  ds_read_b128 v[40:43], v13 offset:0
  ds_read_b128 v[44:47], v13 offset:2048
  v_mfma_f32_16x16x32_bf16 v[24:27], v[64:67], v[60:63], v[24:27]
  ds_read_b64_tr_b16 v[48:49], v16 offset:8192
  ds_read_b64_tr_b16 v[50:51], v16 offset:8704
  s_add_u32 m0, s51, 40960
  s_nop 0
  buffer_load_dwordx4 v11, s[32:35], s62 offen lds
  s_add_u32 s62, s62, 65536
  v_mfma_f32_16x16x32_bf16 v[28:31], v[68:71], v[56:59], v[28:31]
  ds_read_b64_tr_b16 v[52:53], v17 offset:8192
  ds_read_b64_tr_b16 v[54:55], v17 offset:8704
  v_mfma_f32_16x16x32_bf16 v[32:35], v[68:71], v[60:63], v[32:35]
  s_add_u32 m0, s51, 32768
  s_nop 0
  buffer_load_dwordx4 v10, s[28:31], s61 offen sc1 lds
  s_add_u32 s61, s61, 128
  s_waitcnt lgkmcnt(0)
  v_mfma_f32_16x16x32_bf16 v[20:23], v[48:51], v[40:43], v[20:23]
  ds_read_b128 v[56:59], v13 offset:16384
  ds_read_b128 v[60:63], v13 offset:18432
  v_mfma_f32_16x16x32_bf16 v[24:27], v[48:51], v[44:47], v[24:27]
  ds_read_b64_tr_b16 v[64:65], v16 offset:24576
  ds_read_b64_tr_b16 v[66:67], v16 offset:25088
  s_add_u32 m0, s51, 57344
  s_nop 0
  buffer_load_dwordx4 v11, s[32:35], s62 offen lds
  s_add_u32 s62, s62, 65536
  v_mfma_f32_16x16x32_bf16 v[28:31], v[52:55], v[40:43], v[28:31]
  ds_read_b64_tr_b16 v[68:69], v17 offset:24576
  ds_read_b64_tr_b16 v[70:71], v17 offset:25088
  v_mfma_f32_16x16x32_bf16 v[32:35], v[52:55], v[44:47], v[32:35]
  s_add_u32 m0, s51, 49152
  s_nop 0
  buffer_load_dwordx4 v10, s[28:31], s61 offen sc1 lds
  s_add_u32 s61, s61, 128
  s_waitcnt lgkmcnt(0)
  s_waitcnt vmcnt(8)
  s_barrier
  v_mfma_f32_16x16x32_bf16 v[20:23], v[64:67], v[56:59], v[20:23]
  ds_read_b128 v[40:43], v13 offset:32768
  ds_read_b128 v[44:47], v13 offset:34816
  v_mfma_f32_16x16x32_bf16 v[24:27], v[64:67], v[60:63], v[24:27]
  ds_read_b64_tr_b16 v[48:49], v16 offset:40960
  ds_read_b64_tr_b16 v[50:51], v16 offset:41472
  v_mfma_f32_16x16x32_bf16 v[28:31], v[68:71], v[56:59], v[28:31]
  ds_read_b64_tr_b16 v[52:53], v17 offset:40960
  ds_read_b64_tr_b16 v[54:55], v17 offset:41472
  v_mfma_f32_16x16x32_bf16 v[32:35], v[68:71], v[60:63], v[32:35]
  s_waitcnt lgkmcnt(0)
  v_mfma_f32_16x16x32_bf16 v[20:23], v[48:51], v[40:43], v[20:23]
  ds_read_b128 v[56:59], v13 offset:49152
  ds_read_b128 v[60:63], v13 offset:51200
  v_mfma_f32_16x16x32_bf16 v[24:27], v[48:51], v[44:47], v[24:27]
  ds_read_b64_tr_b16 v[64:65], v16 offset:57344
  ds_read_b64_tr_b16 v[66:67], v16 offset:57856
  v_mfma_f32_16x16x32_bf16 v[28:31], v[52:55], v[40:43], v[28:31]
  ds_read_b64_tr_b16 v[68:69], v17 offset:57344
  ds_read_b64_tr_b16 v[70:71], v17 offset:57856
  v_mfma_f32_16x16x32_bf16 v[32:35], v[52:55], v[44:47], v[32:35]
  s_waitcnt lgkmcnt(0)
  s_waitcnt vmcnt(4)
  s_barrier
  v_mfma_f32_16x16x32_bf16 v[20:23], v[64:67], v[56:59], v[20:23]
  ds_read_b128 v[40:43], v12 offset:0
  ds_read_b128 v[44:47], v12 offset:2048
  v_mfma_f32_16x16x32_bf16 v[24:27], v[64:67], v[60:63], v[24:27]
  ds_read_b64_tr_b16 v[48:49], v14 offset:8192
  ds_read_b64_tr_b16 v[50:51], v14 offset:8704
  v_mfma_f32_16x16x32_bf16 v[28:31], v[68:71], v[56:59], v[28:31]
  ds_read_b64_tr_b16 v[52:53], v15 offset:8192
  ds_read_b64_tr_b16 v[54:55], v15 offset:8704
  v_mfma_f32_16x16x32_bf16 v[32:35], v[68:71], v[60:63], v[32:35]
  s_waitcnt lgkmcnt(0)
  v_mfma_f32_16x16x32_bf16 v[20:23], v[48:51], v[40:43], v[20:23]
  ds_read_b128 v[56:59], v12 offset:16384
  ds_read_b128 v[60:63], v12 offset:18432
  v_mfma_f32_16x16x32_bf16 v[24:27], v[48:51], v[44:47], v[24:27]
  ds_read_b64_tr_b16 v[64:65], v14 offset:24576
  ds_read_b64_tr_b16 v[66:67], v14 offset:25088
  v_mfma_f32_16x16x32_bf16 v[28:31], v[52:55], v[40:43], v[28:31]
  ds_read_b64_tr_b16 v[68:69], v15 offset:24576
  ds_read_b64_tr_b16 v[70:71], v15 offset:25088
  v_mfma_f32_16x16x32_bf16 v[32:35], v[52:55], v[44:47], v[32:35]
  s_waitcnt lgkmcnt(0)
  s_waitcnt vmcnt(0)
  s_barrier
  v_mfma_f32_16x16x32_bf16 v[20:23], v[64:67], v[56:59], v[20:23]
  ds_read_b128 v[40:43], v12 offset:32768
  ds_read_b128 v[44:47], v12 offset:34816
  v_mfma_f32_16x16x32_bf16 v[24:27], v[64:67], v[60:63], v[24:27]
  ds_read_b64_tr_b16 v[48:49], v14 offset:40960
  ds_read_b64_tr_b16 v[50:51], v14 offset:41472
  v_mfma_f32_16x16x32_bf16 v[28:31], v[68:71], v[56:59], v[28:31]
  ds_read_b64_tr_b16 v[52:53], v15 offset:40960
  ds_read_b64_tr_b16 v[54:55], v15 offset:41472
  v_mfma_f32_16x16x32_bf16 v[32:35], v[68:71], v[60:63], v[32:35]
  s_waitcnt lgkmcnt(0)
  v_mfma_f32_16x16x32_bf16 v[20:23], v[48:51], v[40:43], v[20:23]
  ds_read_b128 v[56:59], v12 offset:49152
  ds_read_b128 v[60:63], v12 offset:51200
  v_mfma_f32_16x16x32_bf16 v[24:27], v[48:51], v[44:47], v[24:27]
  ds_read_b64_tr_b16 v[64:65], v14 offset:57344
  ds_read_b64_tr_b16 v[66:67], v14 offset:57856
  v_mfma_f32_16x16x32_bf16 v[28:31], v[52:55], v[40:43], v[28:31]
  ds_read_b64_tr_b16 v[68:69], v15 offset:57344
  ds_read_b64_tr_b16 v[70:71], v15 offset:57856
  v_mfma_f32_16x16x32_bf16 v[32:35], v[52:55], v[44:47], v[32:35]
  s_waitcnt lgkmcnt(0)
  v_mfma_f32_16x16x32_bf16 v[20:23], v[64:67], v[56:59], v[20:23]
  v_mfma_f32_16x16x32_bf16 v[24:27], v[64:67], v[60:63], v[24:27]
  v_mfma_f32_16x16x32_bf16 v[28:31], v[68:71], v[56:59], v[28:31]
  v_mfma_f32_16x16x32_bf16 v[32:35], v[68:71], v[60:63], v[32:35]
  s_nop 4
  ds_write_b128 v72, v[20:23] offset:0
  ds_write_b128 v72, v[24:27] offset:4096
  ds_write_b128 v73, v[28:31] offset:0
  ds_write_b128 v73, v[32:35] offset:4096
  v_lshlrev_b32 v56, 16, v252
  v_and_b32 v57, 0xffff0000, v252
  v_lshlrev_b32 v58, 16, v253
  v_and_b32 v59, 0xffff0000, v253
  v_lshlrev_b32 v60, 16, v254
  v_and_b32 v61, 0xffff0000, v254
  v_lshlrev_b32 v62, 16, v255
  v_and_b32 v63, 0xffff0000, v255
  s_waitcnt lgkmcnt(0)
  s_barrier
  ds_read_b128 v[40:43], v74
  ds_read_b128 v[44:47], v75
  ds_read_b128 v[48:51], v74 offset:16384
  ds_read_b128 v[52:55], v75 offset:16384
  s_waitcnt lgkmcnt(2)
  v_pk_add_f32 v[40:41], v[40:41], v[56:57]
  v_pk_add_f32 v[42:43], v[42:43], v[58:59]
  v_pk_add_f32 v[44:45], v[44:45], v[60:61]
  v_pk_add_f32 v[46:47], v[46:47], v[62:63]
  s_waitcnt lgkmcnt(0)
  v_pk_add_f32 v[40:41], v[40:41], v[48:49]
  v_pk_add_f32 v[42:43], v[42:43], v[50:51]
  v_pk_add_f32 v[44:45], v[44:45], v[52:53]
  v_pk_add_f32 v[46:47], v[46:47], v[54:55]
  v_cvt_pk_bf16_f32 v64, v40, v41
  v_cvt_pk_bf16_f32 v65, v42, v43
  v_cvt_pk_bf16_f32 v66, v44, v45
  v_cvt_pk_bf16_f32 v67, v46, v47
  buffer_store_dwordx4 v[64:67], v8, s[40:43], 0 offen
  s_waitcnt vmcnt(0)
Lend:
  s_endpgm
.section .rodata,"a"
.p2align 6
.amdhsa_kernel sequential_preLN__sliding_block__geglu_ffn__prompt_kernel
  .amdhsa_next_free_vgpr 256
  .amdhsa_next_free_sgpr 102
  .amdhsa_accum_offset 256
  .amdhsa_group_segment_fixed_size 0
  .amdhsa_kernarg_size 80
  .amdhsa_user_sgpr_count 2
  .amdhsa_user_sgpr_kernarg_segment_ptr 1
  .amdhsa_system_sgpr_workgroup_id_x 1
.end_amdhsa_kernel
```
